```python
import torch

def _softmax(x, axis=-1):
    return torch.softmax(x, dim=axis)

def _gelu(x):
    return torch.nn.functional.gelu(x, approximate='tanh')

def _silu(x):
    return torch.nn.functional.silu(x)

def _sigmoid(x):
    return torch.sigmoid(x)

def _layernorm(x, axis=-1, eps=1e-05):
    m = x.mean(dim=axis, keepdim=True)
    v = x.var(dim=axis, keepdim=True, unbiased=False)
    return (x - m) / torch.sqrt(v + eps)

def _scatter_add(tgt, idx, src, axis=0):
    return tgt.clone().index_add_(axis, idx, src)

def _segment_sum(src, seg, n):
    out = torch.zeros((n,) + src.shape[1:], dtype=src.dtype)
    return out.index_add_(0, seg, src)

def _pad(x, pw):
    flat = tuple((v for pair in reversed(pw) for v in pair))
    return torch.nn.functional.pad(x, flat)
kernel_name = 'adaLN_cond__mha_block__moe_arch_mod__prompt'

def setup_inputs():

    _w = lambda a: (lambda t: t.to(torch.bfloat16) if t.is_floating_point() else t)(torch.as_tensor(a))

    def _A_setup():
        B, S, D, H = (1, 2048, 512, 32)
        return {'x': _w((lambda *s: torch.randn(*s, dtype=torch.bfloat16) * 0.05)(B, S, D)), 'wqkv': _w((lambda *s: torch.randn(*s, dtype=torch.bfloat16) * 0.05)(D, 3 * D)), 'wo': _w((lambda *s: torch.randn(*s, dtype=torch.bfloat16) * 0.05)(D, D))}
    _A_in = _A_setup()

    def _B_setup():
        B, S, D, F, C = (1, 2048, 512, 1792, 1)
        return {'x': _w((lambda *s: torch.randn(*s, dtype=torch.bfloat16) * 0.05)(B, S, D)), 'w_r': _w((lambda *s: torch.randn(*s, dtype=torch.bfloat16) * 0.05)(D)), 'w_gate': _w((lambda *s: torch.randn(*s, dtype=torch.bfloat16) * 0.05)(D, F)), 'w_up': _w((lambda *s: torch.randn(*s, dtype=torch.bfloat16) * 0.05)(D, F)), 'w_down': _w((lambda *s: torch.randn(*s, dtype=torch.bfloat16) * 0.05)(F, D))}
    _B_in = _B_setup()
    return {'A_x': _A_in['x'], 'A_wqkv': _A_in['wqkv'], 'A_wo': _A_in['wo'], 'B_x': _B_in['x'], 'B_w_r': _B_in['w_r'], 'B_w_gate': _B_in['w_gate'], 'B_w_up': _B_in['w_up'], 'B_w_down': _B_in['w_down'], 'c': _w((lambda *s: torch.randn(*s, dtype=torch.bfloat16) * 0.1)(1, 512) * 8.0), 'w_mod': _w((lambda *s: torch.randn(*s, dtype=torch.bfloat16) * 0.1)(512, 6 * 512) * 512 ** (-0.5) * 8.0)}

def reference(A_x, A_wqkv, A_wo, B_x, B_w_r, B_w_gate, B_w_up, B_w_down, c, w_mod):

    def _A_ref(x, wqkv, wo):
        B, S, D = x.shape
        H = 32
        Dh = D // H
        qkv = (lambda x, *d: x.permute(*d))((x @ wqkv).reshape(B, S, 3, H, Dh), 2, 0, 3, 1, 4)
        q, k, v = (qkv[0], qkv[1], qkv[2])
        scores = torch.einsum('bhqd,bhkd->bhqk', q, k) * Dh ** (-0.5)
        p = _softmax(scores, axis=-1)
        o = torch.einsum('bhqk,bhkd->bhqd', p, v)
        return (lambda x, *d: x.permute(*d))(o, 0, 2, 1, 3).reshape(B, S, D) @ wo

    def _B_ref(x, w_r, w_gate, w_up, w_down):
        B, S, D = x.shape
        C = 1
        r = x @ w_r
        idx = torch.argsort(-r, axis=-1)[:, :C]
        idx_e = (lambda x, n, axis: torch.repeat_interleave(x, n, dim=axis))(idx.reshape(B, C, 1), D, axis=2)
        x_sel = (lambda x, i, axis: torch.take_along_dim(x, i, dim=axis))(x, idx_e, axis=1)
        g = _silu(x_sel @ w_gate)
        u = x_sel @ w_up
        y = g * u @ w_down
        r_sel = _sigmoid((lambda x, i, axis: torch.take_along_dim(x, i, dim=axis))(r, idx, axis=1))
        y = y * r_sel.reshape(B, C, 1)
        b_off = (torch.arange(B) * S).reshape(B, 1)
        flat_idx = (idx + b_off).reshape(B * C)
        zero = (x * 0.0).reshape(B * S, D)
        upd = _scatter_add(zero, flat_idx, y.reshape(B * C, D), axis=0)
        return x + upd.reshape(B, S, D)
    x = A_x
    mod = (_silu(c) @ w_mod).reshape(c.shape[0], 6, 1, -1)
    sa, ca, ga, sb, cb, gb = (mod[:, 0].clone(), mod[:, 1].clone(), mod[:, 2].clone(), mod[:, 3].clone(), mod[:, 4].clone(), mod[:, 5].clone())
    h = _layernorm(x, axis=-1) * (1 + ca) + sa
    x = x + ga * _A_ref(h, A_wqkv, A_wo)
    h = _layernorm(x, axis=-1) * (1 + cb) + sb
    x = x + gb * _B_ref(h, B_w_r, B_w_gate, B_w_up, B_w_down)
    return x
```

```asm
; @launch grid=(256,1,1) block=(512,1,1) lds=163840
.amdgcn_target "amdgcn-amd-amdhsa--gfx950"
.text
.globl adaLN_cond__mha_block__moe_arch_mod__prompt_kernel
.p2align 8
.type adaLN_cond__mha_block__moe_arch_mod__prompt_kernel,@function
adaLN_cond__mha_block__moe_arch_mod__prompt_kernel:
  s_cmp_ge_u32 s2, 256
  s_cbranch_scc1 L_end
  s_load_dwordx16 s[8:23], s[0:1], 0
  s_load_dwordx8 s[24:31], s[0:1], 64
  s_load_dwordx2 s[32:33], s[0:1], 96
  v_and_b32 v1, 63, v0
  v_lshrrev_b32 v2, 6, v0
  s_and_b32 s98, s2, 7
  s_lshr_b32 s99, s2, 3
  v_readfirstlane_b32 s82, v2
  s_and_b32 s80, s99, 3
  s_lshr_b32 s84, s99, 2
  s_and_b32 s85, s98, 1
  s_lshl_b32 s85, s85, 2
  s_add_u32 s80, s80, s85
  s_lshr_b32 s81, s98, 1
  s_lshl_b32 s81, s81, 3
  s_add_u32 s81, s81, s84
  s_and_b32 s6, s84, 7
  s_and_b32 s3, s82, 3
  s_add_u32 s4, s3, s99
  s_and_b32 s4, s4, 3
  v_lshrrev_b32 v96, 1, v1
  v_and_b32 v97, 1, v1
  v_lshlrev_b32 v97, 4, v97
  v_mul_u32_u24 v91, 6144, v96
  v_add_u32 v91, v91, v97
  v_lshlrev_b32 v92, 1, v96
  v_mul_u32_u24 v90, 3072, v96
  v_add_u32 v90, v90, v97
  v_lshlrev_b32 v93, 3, v96
  v_lshlrev_b32 v100, 4, v1
  v_mov_b32 v96, 0x3f803f80
  v_lshlrev_b32 v97, 2, v0
  v_cmp_gt_u32 vcc, 256, v0
  s_nop 0
  s_and_saveexec_b64 s[88:89], vcc
  v_add_u32 v98, 155648, v97
  ds_write_b32 v98, v96
  v_mov_b32 v96, 0
  v_cmp_gt_u32 vcc, 8, v0
  s_nop 0
  s_and_b64 exec, exec, vcc
  ds_write_b32 v98, v96 offset:5184
  s_mov_b64 exec, s[88:89]
  s_mul_i32 s86, s4, 393216
  s_mul_i32 s87, s81, 32
  s_add_u32 s86, s86, s87
  s_and_b32 s90, s98, 1
  s_lshl_b32 s90, s90, 2
  s_lshr_b32 s88, s98, 1
  s_add_u32 s90, s90, s88
  s_lshl_b32 s90, s90, 5
  s_add_u32 s90, s90, s99
  s_lshl_b32 s88, s90, 2
  s_add_u32 s88, s88, s3
  s_lshl_b32 s88, s88, 11
  s_waitcnt lgkmcnt(0)
  s_load_dword s83, s[32:33], 0
  s_cmp_ge_u32 s82, 4
  s_cbranch_scc1 Lloader_1
  s_mov_b32 s40, s10
  s_and_b32 s41, s11, 0xffff
  s_mov_b32 s42, 0x00180000
  s_mov_b32 s43, 0x00020000
  s_cmp_lg_u32 s82, 0
  s_cbranch_scc1 Ltw_3
  s_mov_b32 s76, s32
  s_and_b32 s77, s33, 0xffff
  s_mov_b32 s78, 0x01000000
  s_mov_b32 s79, 0x00020000
  v_lshlrev_b32 v8, 20, v1
  s_mov_b32 exec_lo, 0x0000ffff
  s_mov_b32 exec_hi, 0x00000000
  buffer_load_dword v9, v8, s[76:79], 0 offen
  s_mov_b32 exec_lo, 0x00000001
  s_mov_b32 exec_hi, 0x00000000
  v_mov_b32 v8, 0
  s_mov_b32 s44, s12
  s_and_b32 s45, s13, 0xffff
  s_mov_b32 s46, 0x00080000
  s_mov_b32 s47, 0x00020000
  buffer_load_dword v10, v8, s[44:47], 0 offen
  s_mov_b32 s48, s16
  s_and_b32 s49, s17, 0xffff
  s_mov_b32 s50, 0x00000400
  s_mov_b32 s51, 0x00020000
  buffer_load_dword v11, v8, s[48:51], 0 offen
  s_mov_b32 s52, s18
  s_and_b32 s53, s19, 0xffff
  s_mov_b32 s54, 0x001c0000
  s_mov_b32 s55, 0x00020000
  buffer_load_dword v12, v8, s[52:55], 0 offen
  s_mov_b32 s56, s20
  s_and_b32 s57, s21, 0xffff
  s_mov_b32 s58, 0x001c0000
  s_mov_b32 s59, 0x00020000
  buffer_load_dword v13, v8, s[56:59], 0 offen
  s_mov_b32 s60, s22
  s_and_b32 s61, s23, 0xffff
  s_mov_b32 s62, 0x001c0000
  s_mov_b32 s63, 0x00020000
  buffer_load_dword v14, v8, s[60:63], 0 offen
  s_mov_b32 s72, s28
  s_and_b32 s73, s29, 0xffff
  s_mov_b32 s74, 0x00200000
  s_mov_b32 s75, 0x00020000
  buffer_load_dword v15, v8, s[72:75], 0 offen
  s_mov_b64 exec, -1
Ltw_3:
  s_barrier
  s_cmp_lt_u32 s98, 2
  s_cbranch_scc0 Lhold_4
  s_cmp_lg_u32 s82, 0
  s_cbranch_scc1 Lw0_5
  s_mul_i32 s84, s99, 48
  v_add_u32 v104, s84, v1
  v_mul_u32_u24 v105, 21846, v104
  v_lshrrev_b32 v105, 16, v105
  v_mul_u32_u24 v106, 3, v105
  v_sub_u32 v106, v104, v106
  v_mul_u32_u24 v105, 3072, v105
  v_lshl_add_u32 v105, v106, 10, v105
  s_lshr_b32 s84, s98, 1
  s_lshl_b32 s84, s84, 8
  s_mov_b32 exec_lo, 0xffffffff
  s_mov_b32 exec_hi, 0x0000ffff
  buffer_load_dword v8, v105, s[40:43], s84 offen offset:0
  buffer_load_dword v8, v105, s[40:43], s84 offen offset:128
  s_mov_b64 exec, -1
Lw0_5:
  s_barrier
Lhold_4:
  buffer_load_dwordx4 v[16:19], v90, s[40:43], s86 offen offset:0
  buffer_load_dwordx4 v[20:23], v90, s[40:43], s86 offen offset:1024
  buffer_load_dwordx4 v[24:27], v90, s[40:43], s86 offen offset:2048
  s_add_u32 s86, s86, 98304
  buffer_load_dwordx4 v[28:31], v90, s[40:43], s86 offen offset:0
  buffer_load_dwordx4 v[32:35], v90, s[40:43], s86 offen offset:1024
  buffer_load_dwordx4 v[36:39], v90, s[40:43], s86 offen offset:2048
  s_add_u32 s86, s86, 98304
  buffer_load_dwordx4 v[40:43], v90, s[40:43], s86 offen offset:0
  buffer_load_dwordx4 v[44:47], v90, s[40:43], s86 offen offset:1024
  buffer_load_dwordx4 v[48:51], v90, s[40:43], s86 offen offset:2048
  s_mov_b32 s76, s32
  s_and_b32 s77, s33, 0xffff
  s_mov_b32 s78, 0x01000000
  s_mov_b32 s79, 0x00020000
  s_mov_b32 s44, s12
  s_and_b32 s45, s13, 0xffff
  s_mov_b32 s46, 0x00080000
  s_mov_b32 s47, 0x00020000
  s_mov_b32 s48, s16
  s_and_b32 s49, s17, 0xffff
  s_mov_b32 s50, 0x00000400
  s_mov_b32 s51, 0x00020000
  s_mov_b32 s52, s18
  s_and_b32 s53, s19, 0xffff
  s_mov_b32 s54, 0x001c0000
  s_mov_b32 s55, 0x00020000
  s_mov_b32 s56, s20
  s_and_b32 s57, s21, 0xffff
  s_mov_b32 s58, 0x001c0000
  s_mov_b32 s59, 0x00020000
  s_mov_b32 s60, s22
  s_and_b32 s61, s23, 0xffff
  s_mov_b32 s62, 0x001c0000
  s_mov_b32 s63, 0x00020000
  s_mov_b32 s72, s28
  s_and_b32 s73, s29, 0xffff
  s_mov_b32 s74, 0x00200000
  s_mov_b32 s75, 0x00020000
  s_mov_b32 s36, s8
  s_and_b32 s37, s9, 0xffff
  s_mov_b32 s38, 0x00200000
  s_mov_b32 s39, 0x00020000
  s_mov_b32 s64, s24
  s_and_b32 s65, s25, 0xffff
  s_mov_b32 s66, 0x00000400
  s_mov_b32 s67, 0x00020000
  s_mov_b32 s68, s26
  s_and_b32 s69, s27, 0xffff
  s_mov_b32 s70, 0x00300000
  s_mov_b32 s71, 0x00020000
  s_lshl_b32 s89, s4, 10
  s_add_u32 s89, s89, 4096
  s_add_u32 s85, s89, 4096
  buffer_load_dwordx2 v[64:65], v93, s[76:79], s85 offen offset:0 sc1
  buffer_load_dwordx2 v[66:67], v93, s[76:79], s85 offen offset:256 sc1
  buffer_load_dwordx2 v[68:69], v93, s[76:79], s85 offen offset:512 sc1
  buffer_load_dwordx2 v[70:71], v93, s[76:79], s85 offen offset:768 sc1
  buffer_load_dwordx2 v[72:73], v93, s[76:79], s89 offen offset:0 sc1
  buffer_load_dwordx2 v[74:75], v93, s[76:79], s89 offen offset:256 sc1
  buffer_load_dwordx2 v[76:77], v93, s[76:79], s89 offen offset:512 sc1
  buffer_load_dwordx2 v[78:79], v93, s[76:79], s89 offen offset:768 sc1
  s_add_u32 s86, s86, 98304
  buffer_load_dwordx4 v[52:55], v90, s[40:43], s86 offen offset:0
  buffer_load_dwordx4 v[56:59], v90, s[40:43], s86 offen offset:1024
  buffer_load_dwordx4 v[60:63], v90, s[40:43], s86 offen offset:2048
  s_barrier
  s_waitcnt lgkmcnt(0)
  s_mul_i32 s83, s83, 0x9E3779B1
  s_add_u32 s83, s83, 0x7F4A7C15
  v_lshrrev_b32 v103, 4, v1
  v_lshlrev_b32 v88, 8, v103
  v_bfe_u32 v111, v1, 2, 2
  v_lshl_add_u32 v88, v111, 5, v88
  v_and_b32 v111, 3, v1
  v_lshl_add_u32 v88, v111, 3, v88
  v_and_b32 v111, 1, v103
  v_lshlrev_b32 v111, 7, v111
  v_xor_b32 v88, v88, v111
  v_xor_b32 v89, 128, v88
  v_add_u32 v88, 98304, v88
  v_add_u32 v89, 98304, v89
  v_and_b32 v96, 15, v1
  s_mul_i32 s11, s3, 24576
  v_lshrrev_b32 v98, 1, v96
  v_xor_b32 v98, v98, v103
  v_lshlrev_b32 v97, 7, v96
  v_lshl_add_u32 v124, v98, 4, v97
  v_xor_b32 v125, 64, v124
  v_add_u32 v124, s11, v124
  v_add_u32 v125, s11, v125
  v_lshlrev_b32 v114, 4, v1
  v_bfe_u32 v115, v1, 4, 1
  v_lshlrev_b32 v115, 7, v115
  v_xor_b32 v116, v114, v115
  s_lshl_b32 s86, s4, 1
  s_add_u32 s86, s86, 0
  s_sub_u32 s86, s86, s6
  s_and_b32 s86, s86, 7
  s_lshl_b32 s87, s86, 11
  s_add_u32 s87, s87, 98304
  v_add_u32 v114, s87, v116
  s_lshl_b32 s87, s86, 7
  s_add_u32 s87, s87, 156672
  v_add_u32 v117, s87, v92
  s_lshl_b32 s86, s4, 1
  s_add_u32 s86, s86, 1
  s_sub_u32 s86, s86, s6
  s_and_b32 s86, s86, 7
  s_lshl_b32 s87, s86, 11
  s_add_u32 s87, s87, 98304
  v_add_u32 v115, s87, v116
  s_lshl_b32 s87, s86, 7
  s_add_u32 s87, s87, 156672
  v_add_u32 v118, s87, v92
  s_waitcnt vmcnt(19)
  v_lshlrev_b32 v128, 16, v16
  v_and_b32 v129, 0xffff0000, v16
  v_lshlrev_b32 v130, 16, v17
  v_and_b32 v131, 0xffff0000, v17
  v_lshlrev_b32 v132, 16, v18
  v_and_b32 v133, 0xffff0000, v18
  v_lshlrev_b32 v134, 16, v19
  v_and_b32 v135, 0xffff0000, v19
  s_waitcnt vmcnt(18)
  v_lshlrev_b32 v136, 16, v20
  v_and_b32 v137, 0xffff0000, v20
  v_lshlrev_b32 v138, 16, v21
  v_and_b32 v139, 0xffff0000, v21
  v_lshlrev_b32 v140, 16, v22
  v_and_b32 v141, 0xffff0000, v22
  v_lshlrev_b32 v142, 16, v23
  v_and_b32 v143, 0xffff0000, v23
  s_waitcnt vmcnt(17)
  v_lshlrev_b32 v144, 16, v24
  v_and_b32 v145, 0xffff0000, v24
  v_lshlrev_b32 v146, 16, v25
  v_and_b32 v147, 0xffff0000, v25
  v_lshlrev_b32 v148, 16, v26
  v_and_b32 v149, 0xffff0000, v26
  v_lshlrev_b32 v150, 16, v27
  v_and_b32 v151, 0xffff0000, v27
  s_waitcnt vmcnt(16)
  v_lshlrev_b32 v152, 16, v28
  v_and_b32 v153, 0xffff0000, v28
  v_lshlrev_b32 v154, 16, v29
  v_and_b32 v155, 0xffff0000, v29
  v_lshlrev_b32 v156, 16, v30
  v_and_b32 v157, 0xffff0000, v30
  v_lshlrev_b32 v158, 16, v31
  v_and_b32 v159, 0xffff0000, v31
  s_waitcnt vmcnt(15)
  v_lshlrev_b32 v160, 16, v32
  v_and_b32 v161, 0xffff0000, v32
  v_lshlrev_b32 v162, 16, v33
  v_and_b32 v163, 0xffff0000, v33
  v_lshlrev_b32 v164, 16, v34
  v_and_b32 v165, 0xffff0000, v34
  v_lshlrev_b32 v166, 16, v35
  v_and_b32 v167, 0xffff0000, v35
  s_waitcnt vmcnt(14)
  v_lshlrev_b32 v168, 16, v36
  v_and_b32 v169, 0xffff0000, v36
  v_lshlrev_b32 v170, 16, v37
  v_and_b32 v171, 0xffff0000, v37
  v_lshlrev_b32 v172, 16, v38
  v_and_b32 v173, 0xffff0000, v38
  v_lshlrev_b32 v174, 16, v39
  v_and_b32 v175, 0xffff0000, v39
  s_waitcnt vmcnt(13)
  v_lshlrev_b32 v176, 16, v40
  v_and_b32 v177, 0xffff0000, v40
  v_lshlrev_b32 v178, 16, v41
  v_and_b32 v179, 0xffff0000, v41
  v_lshlrev_b32 v180, 16, v42
  v_and_b32 v181, 0xffff0000, v42
  v_lshlrev_b32 v182, 16, v43
  v_and_b32 v183, 0xffff0000, v43
  s_waitcnt vmcnt(12)
  v_lshlrev_b32 v184, 16, v44
  v_and_b32 v185, 0xffff0000, v44
  v_lshlrev_b32 v186, 16, v45
  v_and_b32 v187, 0xffff0000, v45
  v_lshlrev_b32 v188, 16, v46
  v_and_b32 v189, 0xffff0000, v46
  v_lshlrev_b32 v190, 16, v47
  v_and_b32 v191, 0xffff0000, v47
  s_waitcnt vmcnt(11)
  v_lshlrev_b32 v192, 16, v48
  v_and_b32 v193, 0xffff0000, v48
  v_lshlrev_b32 v194, 16, v49
  v_and_b32 v195, 0xffff0000, v49
  v_lshlrev_b32 v196, 16, v50
  v_and_b32 v197, 0xffff0000, v50
  v_lshlrev_b32 v198, 16, v51
  v_and_b32 v199, 0xffff0000, v51
  s_waitcnt vmcnt(3)
  s_mov_b32 s92, 0
  v_cmp_ne_u32 s[32:33], s83, v65
  v_cmp_ne_u32 vcc, s83, v67
  s_nop 0
  s_or_b64 s[32:33], s[32:33], vcc
  v_cmp_ne_u32 vcc, s83, v69
  s_nop 0
  s_or_b64 s[32:33], s[32:33], vcc
  v_cmp_ne_u32 vcc, s83, v71
  s_nop 0
  s_or_b64 s[32:33], s[32:33], vcc
  v_cmp_ne_u32 vcc, s83, v73
  s_nop 0
  s_or_b64 s[32:33], s[32:33], vcc
  v_cmp_ne_u32 vcc, s83, v75
  s_nop 0
  s_or_b64 s[32:33], s[32:33], vcc
  v_cmp_ne_u32 vcc, s83, v77
  s_nop 0
  s_or_b64 s[32:33], s[32:33], vcc
  v_cmp_ne_u32 vcc, s83, v79
  s_nop 0
  s_or_b64 s[32:33], s[32:33], vcc
Lup_6:
  s_cmp_eq_u64 s[32:33], 0
  s_cbranch_scc1 Lupd_7
  s_add_u32 s92, s92, 1
  s_cmp_ge_u32 s92, 40000
  s_cbranch_scc1 Lupd_7
  s_sleep 1
  s_mov_b64 exec, s[32:33]
  buffer_load_dwordx2 v[64:65], v93, s[76:79], s85 offen offset:0 sc1
  buffer_load_dwordx2 v[66:67], v93, s[76:79], s85 offen offset:256 sc1
  buffer_load_dwordx2 v[68:69], v93, s[76:79], s85 offen offset:512 sc1
  buffer_load_dwordx2 v[70:71], v93, s[76:79], s85 offen offset:768 sc1
  buffer_load_dwordx2 v[72:73], v93, s[76:79], s89 offen offset:0 sc1
  buffer_load_dwordx2 v[74:75], v93, s[76:79], s89 offen offset:256 sc1
  buffer_load_dwordx2 v[76:77], v93, s[76:79], s89 offen offset:512 sc1
  buffer_load_dwordx2 v[78:79], v93, s[76:79], s89 offen offset:768 sc1
  s_waitcnt vmcnt(0)
  v_cmp_ne_u32 s[32:33], s83, v65
  v_cmp_ne_u32 vcc, s83, v67
  s_nop 0
  s_or_b64 s[32:33], s[32:33], vcc
  v_cmp_ne_u32 vcc, s83, v69
  s_nop 0
  s_or_b64 s[32:33], s[32:33], vcc
  v_cmp_ne_u32 vcc, s83, v71
  s_nop 0
  s_or_b64 s[32:33], s[32:33], vcc
  v_cmp_ne_u32 vcc, s83, v73
  s_nop 0
  s_or_b64 s[32:33], s[32:33], vcc
  v_cmp_ne_u32 vcc, s83, v75
  s_nop 0
  s_or_b64 s[32:33], s[32:33], vcc
  v_cmp_ne_u32 vcc, s83, v77
  s_nop 0
  s_or_b64 s[32:33], s[32:33], vcc
  v_cmp_ne_u32 vcc, s83, v79
  s_nop 0
  s_or_b64 s[32:33], s[32:33], vcc
  s_mov_b64 exec, -1
  s_branch Lup_6
Lupd_7:
  v_mov_b32 v81, 0x30800000
  v_add_f32 v80, 1.0, v64
  v_cmp_lt_f32 vcc, abs(v80), v81
  s_nop 1
  v_cndmask_b32 v80, v80, v81, vcc
  v_add_f32 v82, 1.0, v66
  v_cmp_lt_f32 vcc, abs(v82), v81
  s_nop 1
  v_cndmask_b32 v82, v82, v81, vcc
  v_add_f32 v84, 1.0, v68
  v_cmp_lt_f32 vcc, abs(v84), v81
  s_nop 1
  v_cndmask_b32 v84, v84, v81, vcc
  v_add_f32 v86, 1.0, v70
  v_cmp_lt_f32 vcc, abs(v86), v81
  s_nop 1
  v_cndmask_b32 v86, v86, v81, vcc
  v_rcp_f32 v4, v80
  v_rcp_f32 v5, v82
  v_rcp_f32 v6, v84
  v_rcp_f32 v7, v86
  v_mul_f32 v4, v72, v4
  v_mul_f32 v5, v74, v5
  v_mul_f32 v6, v76, v6
  v_mul_f32 v7, v78, v7
  v_cvt_pk_bf16_f32 v4, v4, v4
  v_cvt_pk_bf16_f32 v5, v5, v5
  v_cvt_pk_bf16_f32 v6, v6, v6
  v_cvt_pk_bf16_f32 v7, v7, v7
  s_mov_b32 exec_lo, 0x55555555
  s_mov_b32 exec_hi, 0x55555555
  ds_write_b16 v117, v4 offset:0
  ds_write_b16 v117, v5 offset:64
  ds_write_b16 v118, v6 offset:0
  ds_write_b16 v118, v7 offset:64
  s_mov_b64 exec, -1
  v_pk_mul_f32 v[128:129], v[128:129], v[80:81] op_sel_hi:[1,0]
  v_pk_mul_f32 v[130:131], v[130:131], v[80:81] op_sel_hi:[1,0]
  v_pk_mul_f32 v[132:133], v[132:133], v[80:81] op_sel_hi:[1,0]
  v_pk_mul_f32 v[134:135], v[134:135], v[80:81] op_sel_hi:[1,0]
  v_cvt_pk_bf16_f32 v8, v128, v129
  v_cvt_pk_bf16_f32 v9, v130, v131
  v_cvt_pk_bf16_f32 v10, v132, v133
  v_cvt_pk_bf16_f32 v11, v134, v135
  ds_write_b128 v114, v[8:11] offset:0
  v_pk_mul_f32 v[136:137], v[136:137], v[80:81] op_sel_hi:[1,0]
  v_pk_mul_f32 v[138:139], v[138:139], v[80:81] op_sel_hi:[1,0]
  v_pk_mul_f32 v[140:141], v[140:141], v[80:81] op_sel_hi:[1,0]
  v_pk_mul_f32 v[142:143], v[142:143], v[80:81] op_sel_hi:[1,0]
  v_cvt_pk_bf16_f32 v12, v136, v137
  v_cvt_pk_bf16_f32 v13, v138, v139
  v_cvt_pk_bf16_f32 v14, v140, v141
  v_cvt_pk_bf16_f32 v15, v142, v143
  ds_write_b128 v114, v[12:15] offset:16384
  v_pk_mul_f32 v[144:145], v[144:145], v[80:81] op_sel_hi:[1,0]
  v_pk_mul_f32 v[146:147], v[146:147], v[80:81] op_sel_hi:[1,0]
  v_pk_mul_f32 v[148:149], v[148:149], v[80:81] op_sel_hi:[1,0]
  v_pk_mul_f32 v[150:151], v[150:151], v[80:81] op_sel_hi:[1,0]
  v_cvt_pk_bf16_f32 v8, v144, v145
  v_cvt_pk_bf16_f32 v9, v146, v147
  v_cvt_pk_bf16_f32 v10, v148, v149
  v_cvt_pk_bf16_f32 v11, v150, v151
  ds_write_b128 v114, v[8:11] offset:32768
  v_pk_mul_f32 v[152:153], v[152:153], v[82:83] op_sel_hi:[1,0]
  v_pk_mul_f32 v[154:155], v[154:155], v[82:83] op_sel_hi:[1,0]
  v_pk_mul_f32 v[156:157], v[156:157], v[82:83] op_sel_hi:[1,0]
  v_pk_mul_f32 v[158:159], v[158:159], v[82:83] op_sel_hi:[1,0]
  v_cvt_pk_bf16_f32 v12, v152, v153
  v_cvt_pk_bf16_f32 v13, v154, v155
  v_cvt_pk_bf16_f32 v14, v156, v157
  v_cvt_pk_bf16_f32 v15, v158, v159
  ds_write_b128 v114, v[12:15] offset:1024
  v_pk_mul_f32 v[160:161], v[160:161], v[82:83] op_sel_hi:[1,0]
  v_pk_mul_f32 v[162:163], v[162:163], v[82:83] op_sel_hi:[1,0]
  v_pk_mul_f32 v[164:165], v[164:165], v[82:83] op_sel_hi:[1,0]
  v_pk_mul_f32 v[166:167], v[166:167], v[82:83] op_sel_hi:[1,0]
  v_cvt_pk_bf16_f32 v8, v160, v161
  v_cvt_pk_bf16_f32 v9, v162, v163
  v_cvt_pk_bf16_f32 v10, v164, v165
  v_cvt_pk_bf16_f32 v11, v166, v167
  ds_write_b128 v114, v[8:11] offset:17408
  v_pk_mul_f32 v[168:169], v[168:169], v[82:83] op_sel_hi:[1,0]
  v_pk_mul_f32 v[170:171], v[170:171], v[82:83] op_sel_hi:[1,0]
  v_pk_mul_f32 v[172:173], v[172:173], v[82:83] op_sel_hi:[1,0]
  v_pk_mul_f32 v[174:175], v[174:175], v[82:83] op_sel_hi:[1,0]
  v_cvt_pk_bf16_f32 v12, v168, v169
  v_cvt_pk_bf16_f32 v13, v170, v171
  v_cvt_pk_bf16_f32 v14, v172, v173
  v_cvt_pk_bf16_f32 v15, v174, v175
  ds_write_b128 v114, v[12:15] offset:33792
  v_pk_mul_f32 v[176:177], v[176:177], v[84:85] op_sel_hi:[1,0]
  v_pk_mul_f32 v[178:179], v[178:179], v[84:85] op_sel_hi:[1,0]
  v_pk_mul_f32 v[180:181], v[180:181], v[84:85] op_sel_hi:[1,0]
  v_pk_mul_f32 v[182:183], v[182:183], v[84:85] op_sel_hi:[1,0]
  v_cvt_pk_bf16_f32 v8, v176, v177
  v_cvt_pk_bf16_f32 v9, v178, v179
  v_cvt_pk_bf16_f32 v10, v180, v181
  v_cvt_pk_bf16_f32 v11, v182, v183
  ds_write_b128 v115, v[8:11] offset:0
  v_pk_mul_f32 v[184:185], v[184:185], v[84:85] op_sel_hi:[1,0]
  v_pk_mul_f32 v[186:187], v[186:187], v[84:85] op_sel_hi:[1,0]
  v_pk_mul_f32 v[188:189], v[188:189], v[84:85] op_sel_hi:[1,0]
  v_pk_mul_f32 v[190:191], v[190:191], v[84:85] op_sel_hi:[1,0]
  v_cvt_pk_bf16_f32 v12, v184, v185
  v_cvt_pk_bf16_f32 v13, v186, v187
  v_cvt_pk_bf16_f32 v14, v188, v189
  v_cvt_pk_bf16_f32 v15, v190, v191
  ds_write_b128 v115, v[12:15] offset:16384
  v_pk_mul_f32 v[192:193], v[192:193], v[84:85] op_sel_hi:[1,0]
  v_pk_mul_f32 v[194:195], v[194:195], v[84:85] op_sel_hi:[1,0]
  v_pk_mul_f32 v[196:197], v[196:197], v[84:85] op_sel_hi:[1,0]
  v_pk_mul_f32 v[198:199], v[198:199], v[84:85] op_sel_hi:[1,0]
  v_cvt_pk_bf16_f32 v8, v192, v193
  v_cvt_pk_bf16_f32 v9, v194, v195
  v_cvt_pk_bf16_f32 v10, v196, v197
  v_cvt_pk_bf16_f32 v11, v198, v199
  ds_write_b128 v115, v[8:11] offset:32768
  s_waitcnt vmcnt(2)
  v_lshlrev_b32 v200, 16, v52
  v_and_b32 v201, 0xffff0000, v52
  v_lshlrev_b32 v202, 16, v53
  v_and_b32 v203, 0xffff0000, v53
  v_lshlrev_b32 v204, 16, v54
  v_and_b32 v205, 0xffff0000, v54
  v_lshlrev_b32 v206, 16, v55
  v_and_b32 v207, 0xffff0000, v55
  v_pk_mul_f32 v[200:201], v[200:201], v[86:87] op_sel_hi:[1,0]
  v_pk_mul_f32 v[202:203], v[202:203], v[86:87] op_sel_hi:[1,0]
  v_pk_mul_f32 v[204:205], v[204:205], v[86:87] op_sel_hi:[1,0]
  v_pk_mul_f32 v[206:207], v[206:207], v[86:87] op_sel_hi:[1,0]
  v_cvt_pk_bf16_f32 v12, v200, v201
  v_cvt_pk_bf16_f32 v13, v202, v203
  v_cvt_pk_bf16_f32 v14, v204, v205
  v_cvt_pk_bf16_f32 v15, v206, v207
  ds_write_b128 v115, v[12:15] offset:1024
  s_waitcnt vmcnt(1)
  v_lshlrev_b32 v208, 16, v56
  v_and_b32 v209, 0xffff0000, v56
  v_lshlrev_b32 v210, 16, v57
  v_and_b32 v211, 0xffff0000, v57
  v_lshlrev_b32 v212, 16, v58
  v_and_b32 v213, 0xffff0000, v58
  v_lshlrev_b32 v214, 16, v59
  v_and_b32 v215, 0xffff0000, v59
  v_pk_mul_f32 v[208:209], v[208:209], v[86:87] op_sel_hi:[1,0]
  v_pk_mul_f32 v[210:211], v[210:211], v[86:87] op_sel_hi:[1,0]
  v_pk_mul_f32 v[212:213], v[212:213], v[86:87] op_sel_hi:[1,0]
  v_pk_mul_f32 v[214:215], v[214:215], v[86:87] op_sel_hi:[1,0]
  v_cvt_pk_bf16_f32 v8, v208, v209
  v_cvt_pk_bf16_f32 v9, v210, v211
  v_cvt_pk_bf16_f32 v10, v212, v213
  v_cvt_pk_bf16_f32 v11, v214, v215
  ds_write_b128 v115, v[8:11] offset:17408
  s_waitcnt vmcnt(0)
  v_lshlrev_b32 v216, 16, v60
  v_and_b32 v217, 0xffff0000, v60
  v_lshlrev_b32 v218, 16, v61
  v_and_b32 v219, 0xffff0000, v61
  v_lshlrev_b32 v220, 16, v62
  v_and_b32 v221, 0xffff0000, v62
  v_lshlrev_b32 v222, 16, v63
  v_and_b32 v223, 0xffff0000, v63
  v_pk_mul_f32 v[216:217], v[216:217], v[86:87] op_sel_hi:[1,0]
  v_pk_mul_f32 v[218:219], v[218:219], v[86:87] op_sel_hi:[1,0]
  v_pk_mul_f32 v[220:221], v[220:221], v[86:87] op_sel_hi:[1,0]
  v_pk_mul_f32 v[222:223], v[222:223], v[86:87] op_sel_hi:[1,0]
  v_cvt_pk_bf16_f32 v12, v216, v217
  v_cvt_pk_bf16_f32 v13, v218, v219
  v_cvt_pk_bf16_f32 v14, v220, v221
  v_cvt_pk_bf16_f32 v15, v222, v223
  ds_write_b128 v115, v[12:15] offset:33792
  s_waitcnt lgkmcnt(0)
  s_barrier
  ds_read_b64_tr_b16 v[64:65], v88 offset:0
  ds_read_b64_tr_b16 v[66:67], v89 offset:0
  ds_read_b128 v[224:227], v124 offset:0
  ds_read_b64_tr_b16 v[68:69], v88 offset:16384
  ds_read_b64_tr_b16 v[70:71], v89 offset:16384
  ds_read_b128 v[228:231], v124 offset:2048
  ds_read_b64_tr_b16 v[72:73], v88 offset:32768
  ds_read_b64_tr_b16 v[74:75], v89 offset:32768
  ds_read_b128 v[232:235], v124 offset:4096
  ds_read_b128 v[236:239], v124 offset:6144
  s_waitcnt lgkmcnt(0)
  ds_read_b64_tr_b16 v[76:77], v88 offset:1024
  ds_read_b64_tr_b16 v[78:79], v89 offset:1024
  v_mfma_f32_16x16x32_bf16 v[16:19], v[64:67], v[224:227], 0
  ds_read_b128 v[240:243], v125 offset:0
  ds_read_b64_tr_b16 v[80:81], v88 offset:17408
  v_mfma_f32_16x16x32_bf16 v[32:35], v[68:71], v[224:227], 0
  ds_read_b64_tr_b16 v[82:83], v89 offset:17408
  ds_read_b128 v[244:247], v125 offset:2048
  v_mfma_f32_16x16x32_bf16 v[48:51], v[224:227], v[72:75], 0
  ds_read_b64_tr_b16 v[84:85], v88 offset:33792
  ds_read_b64_tr_b16 v[86:87], v89 offset:33792
  v_mfma_f32_16x16x32_bf16 v[20:23], v[64:67], v[228:231], 0
  ds_read_b128 v[248:251], v125 offset:4096
  ds_read_b128 v[252:255], v125 offset:6144
  v_mfma_f32_16x16x32_bf16 v[36:39], v[68:71], v[228:231], 0
  v_mfma_f32_16x16x32_bf16 v[52:55], v[228:231], v[72:75], 0
  v_mfma_f32_16x16x32_bf16 v[24:27], v[64:67], v[232:235], 0
  v_mfma_f32_16x16x32_bf16 v[40:43], v[68:71], v[232:235], 0
  v_mfma_f32_16x16x32_bf16 v[56:59], v[232:235], v[72:75], 0
  v_mfma_f32_16x16x32_bf16 v[28:31], v[64:67], v[236:239], 0
  v_mfma_f32_16x16x32_bf16 v[44:47], v[68:71], v[236:239], 0
  v_mfma_f32_16x16x32_bf16 v[60:63], v[236:239], v[72:75], 0
  s_waitcnt lgkmcnt(0)
  s_barrier
  ds_read_b64_tr_b16 v[64:65], v88 offset:2048
  ds_read_b64_tr_b16 v[66:67], v89 offset:2048
  v_mfma_f32_16x16x32_bf16 v[16:19], v[76:79], v[240:243], v[16:19]
  ds_read_b128 v[224:227], v124 offset:8192
  ds_read_b64_tr_b16 v[68:69], v88 offset:18432
  v_mfma_f32_16x16x32_bf16 v[32:35], v[80:83], v[240:243], v[32:35]
  ds_read_b64_tr_b16 v[70:71], v89 offset:18432
  ds_read_b128 v[228:231], v124 offset:10240
  v_mfma_f32_16x16x32_bf16 v[48:51], v[240:243], v[84:87], v[48:51]
  ds_read_b64_tr_b16 v[72:73], v88 offset:34816
  ds_read_b64_tr_b16 v[74:75], v89 offset:34816
  v_mfma_f32_16x16x32_bf16 v[20:23], v[76:79], v[244:247], v[20:23]
  ds_read_b128 v[232:235], v124 offset:12288
  ds_read_b128 v[236:239], v124 offset:14336
  v_mfma_f32_16x16x32_bf16 v[36:39], v[80:83], v[244:247], v[36:39]
  v_mfma_f32_16x16x32_bf16 v[52:55], v[244:247], v[84:87], v[52:55]
  v_mfma_f32_16x16x32_bf16 v[24:27], v[76:79], v[248:251], v[24:27]
  v_mfma_f32_16x16x32_bf16 v[40:43], v[80:83], v[248:251], v[40:43]
  v_mfma_f32_16x16x32_bf16 v[56:59], v[248:251], v[84:87], v[56:59]
  v_mfma_f32_16x16x32_bf16 v[28:31], v[76:79], v[252:255], v[28:31]
  v_mfma_f32_16x16x32_bf16 v[44:47], v[80:83], v[252:255], v[44:47]
  v_mfma_f32_16x16x32_bf16 v[60:63], v[252:255], v[84:87], v[60:63]
  s_waitcnt lgkmcnt(0)
  ds_read_b64_tr_b16 v[76:77], v88 offset:3072
  ds_read_b64_tr_b16 v[78:79], v89 offset:3072
  v_mfma_f32_16x16x32_bf16 v[16:19], v[64:67], v[224:227], v[16:19]
  ds_read_b128 v[240:243], v125 offset:8192
  ds_read_b64_tr_b16 v[80:81], v88 offset:19456
  v_mfma_f32_16x16x32_bf16 v[32:35], v[68:71], v[224:227], v[32:35]
  ds_read_b64_tr_b16 v[82:83], v89 offset:19456
  ds_read_b128 v[244:247], v125 offset:10240
  v_mfma_f32_16x16x32_bf16 v[48:51], v[224:227], v[72:75], v[48:51]
  ds_read_b64_tr_b16 v[84:85], v88 offset:35840
  ds_read_b64_tr_b16 v[86:87], v89 offset:35840
  v_mfma_f32_16x16x32_bf16 v[20:23], v[64:67], v[228:231], v[20:23]
  ds_read_b128 v[248:251], v125 offset:12288
  ds_read_b128 v[252:255], v125 offset:14336
  v_mfma_f32_16x16x32_bf16 v[36:39], v[68:71], v[228:231], v[36:39]
  v_mfma_f32_16x16x32_bf16 v[52:55], v[228:231], v[72:75], v[52:55]
  v_mfma_f32_16x16x32_bf16 v[24:27], v[64:67], v[232:235], v[24:27]
  v_mfma_f32_16x16x32_bf16 v[40:43], v[68:71], v[232:235], v[40:43]
  v_mfma_f32_16x16x32_bf16 v[56:59], v[232:235], v[72:75], v[56:59]
  v_mfma_f32_16x16x32_bf16 v[28:31], v[64:67], v[236:239], v[28:31]
  v_mfma_f32_16x16x32_bf16 v[44:47], v[68:71], v[236:239], v[44:47]
  v_mfma_f32_16x16x32_bf16 v[60:63], v[236:239], v[72:75], v[60:63]
  s_waitcnt lgkmcnt(0)
  s_barrier
  ds_read_b64_tr_b16 v[64:65], v88 offset:4096
  ds_read_b64_tr_b16 v[66:67], v89 offset:4096
  v_mfma_f32_16x16x32_bf16 v[16:19], v[76:79], v[240:243], v[16:19]
  ds_read_b128 v[224:227], v124 offset:16384
  ds_read_b64_tr_b16 v[68:69], v88 offset:20480
  v_mfma_f32_16x16x32_bf16 v[32:35], v[80:83], v[240:243], v[32:35]
  ds_read_b64_tr_b16 v[70:71], v89 offset:20480
  ds_read_b128 v[228:231], v124 offset:18432
  v_mfma_f32_16x16x32_bf16 v[48:51], v[240:243], v[84:87], v[48:51]
  ds_read_b64_tr_b16 v[72:73], v88 offset:36864
  ds_read_b64_tr_b16 v[74:75], v89 offset:36864
  v_mfma_f32_16x16x32_bf16 v[20:23], v[76:79], v[244:247], v[20:23]
  ds_read_b128 v[232:235], v124 offset:20480
  ds_read_b128 v[236:239], v124 offset:22528
  v_mfma_f32_16x16x32_bf16 v[36:39], v[80:83], v[244:247], v[36:39]
  v_mfma_f32_16x16x32_bf16 v[52:55], v[244:247], v[84:87], v[52:55]
  v_mfma_f32_16x16x32_bf16 v[24:27], v[76:79], v[248:251], v[24:27]
  v_mfma_f32_16x16x32_bf16 v[40:43], v[80:83], v[248:251], v[40:43]
  v_mfma_f32_16x16x32_bf16 v[56:59], v[248:251], v[84:87], v[56:59]
  v_mfma_f32_16x16x32_bf16 v[28:31], v[76:79], v[252:255], v[28:31]
  v_mfma_f32_16x16x32_bf16 v[44:47], v[80:83], v[252:255], v[44:47]
  v_mfma_f32_16x16x32_bf16 v[60:63], v[252:255], v[84:87], v[60:63]
  s_waitcnt lgkmcnt(0)
  ds_read_b64_tr_b16 v[76:77], v88 offset:5120
  ds_read_b64_tr_b16 v[78:79], v89 offset:5120
  v_mfma_f32_16x16x32_bf16 v[16:19], v[64:67], v[224:227], v[16:19]
  ds_read_b128 v[240:243], v125 offset:16384
  ds_read_b64_tr_b16 v[80:81], v88 offset:21504
  v_mfma_f32_16x16x32_bf16 v[32:35], v[68:71], v[224:227], v[32:35]
  ds_read_b64_tr_b16 v[82:83], v89 offset:21504
  ds_read_b128 v[244:247], v125 offset:18432
  v_mfma_f32_16x16x32_bf16 v[48:51], v[224:227], v[72:75], v[48:51]
  ds_read_b64_tr_b16 v[84:85], v88 offset:37888
  ds_read_b64_tr_b16 v[86:87], v89 offset:37888
  v_mfma_f32_16x16x32_bf16 v[20:23], v[64:67], v[228:231], v[20:23]
  ds_read_b128 v[248:251], v125 offset:20480
  ds_read_b128 v[252:255], v125 offset:22528
  v_mfma_f32_16x16x32_bf16 v[36:39], v[68:71], v[228:231], v[36:39]
  v_mfma_f32_16x16x32_bf16 v[52:55], v[228:231], v[72:75], v[52:55]
  v_mfma_f32_16x16x32_bf16 v[24:27], v[64:67], v[232:235], v[24:27]
  v_mfma_f32_16x16x32_bf16 v[40:43], v[68:71], v[232:235], v[40:43]
  v_mfma_f32_16x16x32_bf16 v[56:59], v[232:235], v[72:75], v[56:59]
  v_mfma_f32_16x16x32_bf16 v[28:31], v[64:67], v[236:239], v[28:31]
  v_mfma_f32_16x16x32_bf16 v[44:47], v[68:71], v[236:239], v[44:47]
  v_mfma_f32_16x16x32_bf16 v[60:63], v[236:239], v[72:75], v[60:63]
  s_waitcnt lgkmcnt(0)
  s_barrier
  ds_read_b64_tr_b16 v[64:65], v88 offset:6144
  ds_read_b64_tr_b16 v[66:67], v89 offset:6144
  v_mfma_f32_16x16x32_bf16 v[16:19], v[76:79], v[240:243], v[16:19]
  ds_read_b128 v[224:227], v124 offset:0
  ds_read_b64_tr_b16 v[68:69], v88 offset:22528
  v_mfma_f32_16x16x32_bf16 v[32:35], v[80:83], v[240:243], v[32:35]
  ds_read_b64_tr_b16 v[70:71], v89 offset:22528
  ds_read_b128 v[228:231], v124 offset:2048
  v_mfma_f32_16x16x32_bf16 v[48:51], v[240:243], v[84:87], v[48:51]
  ds_read_b64_tr_b16 v[72:73], v88 offset:38912
  ds_read_b64_tr_b16 v[74:75], v89 offset:38912
  v_mfma_f32_16x16x32_bf16 v[20:23], v[76:79], v[244:247], v[20:23]
  ds_read_b128 v[232:235], v124 offset:4096
  ds_read_b128 v[236:239], v124 offset:6144
  v_mfma_f32_16x16x32_bf16 v[36:39], v[80:83], v[244:247], v[36:39]
  v_mfma_f32_16x16x32_bf16 v[52:55], v[244:247], v[84:87], v[52:55]
  v_mfma_f32_16x16x32_bf16 v[24:27], v[76:79], v[248:251], v[24:27]
  v_mfma_f32_16x16x32_bf16 v[40:43], v[80:83], v[248:251], v[40:43]
  v_mfma_f32_16x16x32_bf16 v[56:59], v[248:251], v[84:87], v[56:59]
  v_mfma_f32_16x16x32_bf16 v[28:31], v[76:79], v[252:255], v[28:31]
  v_mfma_f32_16x16x32_bf16 v[44:47], v[80:83], v[252:255], v[44:47]
  v_mfma_f32_16x16x32_bf16 v[60:63], v[252:255], v[84:87], v[60:63]
  s_waitcnt lgkmcnt(0)
  ds_read_b64_tr_b16 v[76:77], v88 offset:7168
  ds_read_b64_tr_b16 v[78:79], v89 offset:7168
  v_mfma_f32_16x16x32_bf16 v[16:19], v[64:67], v[224:227], v[16:19]
  ds_read_b128 v[240:243], v125 offset:0
  ds_read_b64_tr_b16 v[80:81], v88 offset:23552
  v_mfma_f32_16x16x32_bf16 v[32:35], v[68:71], v[224:227], v[32:35]
  ds_read_b64_tr_b16 v[82:83], v89 offset:23552
  ds_read_b128 v[244:247], v125 offset:2048
  v_mfma_f32_16x16x32_bf16 v[48:51], v[224:227], v[72:75], v[48:51]
  ds_read_b64_tr_b16 v[84:85], v88 offset:39936
  ds_read_b64_tr_b16 v[86:87], v89 offset:39936
  v_mfma_f32_16x16x32_bf16 v[20:23], v[64:67], v[228:231], v[20:23]
  ds_read_b128 v[248:251], v125 offset:4096
  ds_read_b128 v[252:255], v125 offset:6144
  v_mfma_f32_16x16x32_bf16 v[36:39], v[68:71], v[228:231], v[36:39]
  v_mfma_f32_16x16x32_bf16 v[52:55], v[228:231], v[72:75], v[52:55]
  v_mfma_f32_16x16x32_bf16 v[24:27], v[64:67], v[232:235], v[24:27]
  v_mfma_f32_16x16x32_bf16 v[40:43], v[68:71], v[232:235], v[40:43]
  v_mfma_f32_16x16x32_bf16 v[56:59], v[232:235], v[72:75], v[56:59]
  v_mfma_f32_16x16x32_bf16 v[28:31], v[64:67], v[236:239], v[28:31]
  v_mfma_f32_16x16x32_bf16 v[44:47], v[68:71], v[236:239], v[44:47]
  v_mfma_f32_16x16x32_bf16 v[60:63], v[236:239], v[72:75], v[60:63]
  s_waitcnt lgkmcnt(0)
  s_barrier
  ds_read_b64_tr_b16 v[64:65], v88 offset:8192
  ds_read_b64_tr_b16 v[66:67], v89 offset:8192
  v_mfma_f32_16x16x32_bf16 v[16:19], v[76:79], v[240:243], v[16:19]
  ds_read_b128 v[224:227], v124 offset:8192
  ds_read_b64_tr_b16 v[68:69], v88 offset:24576
  v_mfma_f32_16x16x32_bf16 v[32:35], v[80:83], v[240:243], v[32:35]
  ds_read_b64_tr_b16 v[70:71], v89 offset:24576
  ds_read_b128 v[228:231], v124 offset:10240
  v_mfma_f32_16x16x32_bf16 v[48:51], v[240:243], v[84:87], v[48:51]
  ds_read_b64_tr_b16 v[72:73], v88 offset:40960
  ds_read_b64_tr_b16 v[74:75], v89 offset:40960
  v_mfma_f32_16x16x32_bf16 v[20:23], v[76:79], v[244:247], v[20:23]
  ds_read_b128 v[232:235], v124 offset:12288
  ds_read_b128 v[236:239], v124 offset:14336
  v_mfma_f32_16x16x32_bf16 v[36:39], v[80:83], v[244:247], v[36:39]
  v_mfma_f32_16x16x32_bf16 v[52:55], v[244:247], v[84:87], v[52:55]
  v_mfma_f32_16x16x32_bf16 v[24:27], v[76:79], v[248:251], v[24:27]
  v_mfma_f32_16x16x32_bf16 v[40:43], v[80:83], v[248:251], v[40:43]
  v_mfma_f32_16x16x32_bf16 v[56:59], v[248:251], v[84:87], v[56:59]
  v_mfma_f32_16x16x32_bf16 v[28:31], v[76:79], v[252:255], v[28:31]
  v_mfma_f32_16x16x32_bf16 v[44:47], v[80:83], v[252:255], v[44:47]
  v_mfma_f32_16x16x32_bf16 v[60:63], v[252:255], v[84:87], v[60:63]
  s_waitcnt lgkmcnt(0)
  ds_read_b64_tr_b16 v[76:77], v88 offset:9216
  ds_read_b64_tr_b16 v[78:79], v89 offset:9216
  v_mfma_f32_16x16x32_bf16 v[16:19], v[64:67], v[224:227], v[16:19]
  ds_read_b128 v[240:243], v125 offset:8192
  ds_read_b64_tr_b16 v[80:81], v88 offset:25600
  v_mfma_f32_16x16x32_bf16 v[32:35], v[68:71], v[224:227], v[32:35]
  ds_read_b64_tr_b16 v[82:83], v89 offset:25600
  ds_read_b128 v[244:247], v125 offset:10240
  v_mfma_f32_16x16x32_bf16 v[48:51], v[224:227], v[72:75], v[48:51]
  ds_read_b64_tr_b16 v[84:85], v88 offset:41984
  ds_read_b64_tr_b16 v[86:87], v89 offset:41984
  v_mfma_f32_16x16x32_bf16 v[20:23], v[64:67], v[228:231], v[20:23]
  ds_read_b128 v[248:251], v125 offset:12288
  ds_read_b128 v[252:255], v125 offset:14336
  v_mfma_f32_16x16x32_bf16 v[36:39], v[68:71], v[228:231], v[36:39]
  v_mfma_f32_16x16x32_bf16 v[52:55], v[228:231], v[72:75], v[52:55]
  v_mfma_f32_16x16x32_bf16 v[24:27], v[64:67], v[232:235], v[24:27]
  v_mfma_f32_16x16x32_bf16 v[40:43], v[68:71], v[232:235], v[40:43]
  v_mfma_f32_16x16x32_bf16 v[56:59], v[232:235], v[72:75], v[56:59]
  v_mfma_f32_16x16x32_bf16 v[28:31], v[64:67], v[236:239], v[28:31]
  v_mfma_f32_16x16x32_bf16 v[44:47], v[68:71], v[236:239], v[44:47]
  v_mfma_f32_16x16x32_bf16 v[60:63], v[236:239], v[72:75], v[60:63]
  s_waitcnt lgkmcnt(0)
  s_barrier
  ds_read_b64_tr_b16 v[64:65], v88 offset:10240
  ds_read_b64_tr_b16 v[66:67], v89 offset:10240
  v_mfma_f32_16x16x32_bf16 v[16:19], v[76:79], v[240:243], v[16:19]
  ds_read_b128 v[224:227], v124 offset:16384
  ds_read_b64_tr_b16 v[68:69], v88 offset:26624
  v_mfma_f32_16x16x32_bf16 v[32:35], v[80:83], v[240:243], v[32:35]
  ds_read_b64_tr_b16 v[70:71], v89 offset:26624
  ds_read_b128 v[228:231], v124 offset:18432
  v_mfma_f32_16x16x32_bf16 v[48:51], v[240:243], v[84:87], v[48:51]
  ds_read_b64_tr_b16 v[72:73], v88 offset:43008
  ds_read_b64_tr_b16 v[74:75], v89 offset:43008
  v_mfma_f32_16x16x32_bf16 v[20:23], v[76:79], v[244:247], v[20:23]
  ds_read_b128 v[232:235], v124 offset:20480
  ds_read_b128 v[236:239], v124 offset:22528
  v_mfma_f32_16x16x32_bf16 v[36:39], v[80:83], v[244:247], v[36:39]
  v_mfma_f32_16x16x32_bf16 v[52:55], v[244:247], v[84:87], v[52:55]
  v_mfma_f32_16x16x32_bf16 v[24:27], v[76:79], v[248:251], v[24:27]
  v_mfma_f32_16x16x32_bf16 v[40:43], v[80:83], v[248:251], v[40:43]
  v_mfma_f32_16x16x32_bf16 v[56:59], v[248:251], v[84:87], v[56:59]
  v_mfma_f32_16x16x32_bf16 v[28:31], v[76:79], v[252:255], v[28:31]
  v_mfma_f32_16x16x32_bf16 v[44:47], v[80:83], v[252:255], v[44:47]
  v_mfma_f32_16x16x32_bf16 v[60:63], v[252:255], v[84:87], v[60:63]
  s_waitcnt lgkmcnt(0)
  ds_read_b64_tr_b16 v[76:77], v88 offset:11264
  ds_read_b64_tr_b16 v[78:79], v89 offset:11264
  v_mfma_f32_16x16x32_bf16 v[16:19], v[64:67], v[224:227], v[16:19]
  ds_read_b128 v[240:243], v125 offset:16384
  ds_read_b64_tr_b16 v[80:81], v88 offset:27648
  v_mfma_f32_16x16x32_bf16 v[32:35], v[68:71], v[224:227], v[32:35]
  ds_read_b64_tr_b16 v[82:83], v89 offset:27648
  ds_read_b128 v[244:247], v125 offset:18432
  v_mfma_f32_16x16x32_bf16 v[48:51], v[224:227], v[72:75], v[48:51]
  ds_read_b64_tr_b16 v[84:85], v88 offset:44032
  ds_read_b64_tr_b16 v[86:87], v89 offset:44032
  v_mfma_f32_16x16x32_bf16 v[20:23], v[64:67], v[228:231], v[20:23]
  ds_read_b128 v[248:251], v125 offset:20480
  ds_read_b128 v[252:255], v125 offset:22528
  v_mfma_f32_16x16x32_bf16 v[36:39], v[68:71], v[228:231], v[36:39]
  v_mfma_f32_16x16x32_bf16 v[52:55], v[228:231], v[72:75], v[52:55]
  v_mfma_f32_16x16x32_bf16 v[24:27], v[64:67], v[232:235], v[24:27]
  v_mfma_f32_16x16x32_bf16 v[40:43], v[68:71], v[232:235], v[40:43]
  v_mfma_f32_16x16x32_bf16 v[56:59], v[232:235], v[72:75], v[56:59]
  v_mfma_f32_16x16x32_bf16 v[28:31], v[64:67], v[236:239], v[28:31]
  v_mfma_f32_16x16x32_bf16 v[44:47], v[68:71], v[236:239], v[44:47]
  v_mfma_f32_16x16x32_bf16 v[60:63], v[236:239], v[72:75], v[60:63]
  s_waitcnt lgkmcnt(0)
  s_barrier
  ds_read_b64_tr_b16 v[64:65], v88 offset:12288
  ds_read_b64_tr_b16 v[66:67], v89 offset:12288
  v_mfma_f32_16x16x32_bf16 v[16:19], v[76:79], v[240:243], v[16:19]
  ds_read_b128 v[224:227], v124 offset:0
  ds_read_b64_tr_b16 v[68:69], v88 offset:28672
  v_mfma_f32_16x16x32_bf16 v[32:35], v[80:83], v[240:243], v[32:35]
  ds_read_b64_tr_b16 v[70:71], v89 offset:28672
  ds_read_b128 v[228:231], v124 offset:2048
  v_mfma_f32_16x16x32_bf16 v[48:51], v[240:243], v[84:87], v[48:51]
  ds_read_b64_tr_b16 v[72:73], v88 offset:45056
  ds_read_b64_tr_b16 v[74:75], v89 offset:45056
  v_mfma_f32_16x16x32_bf16 v[20:23], v[76:79], v[244:247], v[20:23]
  ds_read_b128 v[232:235], v124 offset:4096
  ds_read_b128 v[236:239], v124 offset:6144
  v_mfma_f32_16x16x32_bf16 v[36:39], v[80:83], v[244:247], v[36:39]
  v_mfma_f32_16x16x32_bf16 v[52:55], v[244:247], v[84:87], v[52:55]
  v_mfma_f32_16x16x32_bf16 v[24:27], v[76:79], v[248:251], v[24:27]
  v_mfma_f32_16x16x32_bf16 v[40:43], v[80:83], v[248:251], v[40:43]
  v_mfma_f32_16x16x32_bf16 v[56:59], v[248:251], v[84:87], v[56:59]
  v_mfma_f32_16x16x32_bf16 v[28:31], v[76:79], v[252:255], v[28:31]
  v_mfma_f32_16x16x32_bf16 v[44:47], v[80:83], v[252:255], v[44:47]
  v_mfma_f32_16x16x32_bf16 v[60:63], v[252:255], v[84:87], v[60:63]
  s_waitcnt lgkmcnt(0)
  ds_read_b64_tr_b16 v[76:77], v88 offset:13312
  ds_read_b64_tr_b16 v[78:79], v89 offset:13312
  v_mfma_f32_16x16x32_bf16 v[16:19], v[64:67], v[224:227], v[16:19]
  ds_read_b128 v[240:243], v125 offset:0
  ds_read_b64_tr_b16 v[80:81], v88 offset:29696
  v_mfma_f32_16x16x32_bf16 v[32:35], v[68:71], v[224:227], v[32:35]
  ds_read_b64_tr_b16 v[82:83], v89 offset:29696
  ds_read_b128 v[244:247], v125 offset:2048
  v_mfma_f32_16x16x32_bf16 v[48:51], v[224:227], v[72:75], v[48:51]
  ds_read_b64_tr_b16 v[84:85], v88 offset:46080
  ds_read_b64_tr_b16 v[86:87], v89 offset:46080
  v_mfma_f32_16x16x32_bf16 v[20:23], v[64:67], v[228:231], v[20:23]
  ds_read_b128 v[248:251], v125 offset:4096
  ds_read_b128 v[252:255], v125 offset:6144
  v_mfma_f32_16x16x32_bf16 v[36:39], v[68:71], v[228:231], v[36:39]
  v_mfma_f32_16x16x32_bf16 v[52:55], v[228:231], v[72:75], v[52:55]
  v_mfma_f32_16x16x32_bf16 v[24:27], v[64:67], v[232:235], v[24:27]
  v_mfma_f32_16x16x32_bf16 v[40:43], v[68:71], v[232:235], v[40:43]
  v_mfma_f32_16x16x32_bf16 v[56:59], v[232:235], v[72:75], v[56:59]
  v_mfma_f32_16x16x32_bf16 v[28:31], v[64:67], v[236:239], v[28:31]
  v_mfma_f32_16x16x32_bf16 v[44:47], v[68:71], v[236:239], v[44:47]
  v_mfma_f32_16x16x32_bf16 v[60:63], v[236:239], v[72:75], v[60:63]
  s_waitcnt lgkmcnt(0)
  s_barrier
  ds_read_b64_tr_b16 v[64:65], v88 offset:14336
  ds_read_b64_tr_b16 v[66:67], v89 offset:14336
  v_mfma_f32_16x16x32_bf16 v[16:19], v[76:79], v[240:243], v[16:19]
  ds_read_b128 v[224:227], v124 offset:8192
  ds_read_b64_tr_b16 v[68:69], v88 offset:30720
  v_mfma_f32_16x16x32_bf16 v[32:35], v[80:83], v[240:243], v[32:35]
  ds_read_b64_tr_b16 v[70:71], v89 offset:30720
  ds_read_b128 v[228:231], v124 offset:10240
  v_mfma_f32_16x16x32_bf16 v[48:51], v[240:243], v[84:87], v[48:51]
  ds_read_b64_tr_b16 v[72:73], v88 offset:47104
  ds_read_b64_tr_b16 v[74:75], v89 offset:47104
  v_mfma_f32_16x16x32_bf16 v[20:23], v[76:79], v[244:247], v[20:23]
  ds_read_b128 v[232:235], v124 offset:12288
  ds_read_b128 v[236:239], v124 offset:14336
  v_mfma_f32_16x16x32_bf16 v[36:39], v[80:83], v[244:247], v[36:39]
  v_mfma_f32_16x16x32_bf16 v[52:55], v[244:247], v[84:87], v[52:55]
  v_mfma_f32_16x16x32_bf16 v[24:27], v[76:79], v[248:251], v[24:27]
  v_mfma_f32_16x16x32_bf16 v[40:43], v[80:83], v[248:251], v[40:43]
  v_mfma_f32_16x16x32_bf16 v[56:59], v[248:251], v[84:87], v[56:59]
  v_mfma_f32_16x16x32_bf16 v[28:31], v[76:79], v[252:255], v[28:31]
  v_mfma_f32_16x16x32_bf16 v[44:47], v[80:83], v[252:255], v[44:47]
  v_mfma_f32_16x16x32_bf16 v[60:63], v[252:255], v[84:87], v[60:63]
  s_waitcnt lgkmcnt(0)
  ds_read_b64_tr_b16 v[76:77], v88 offset:15360
  ds_read_b64_tr_b16 v[78:79], v89 offset:15360
  v_mfma_f32_16x16x32_bf16 v[16:19], v[64:67], v[224:227], v[16:19]
  ds_read_b128 v[240:243], v125 offset:8192
  ds_read_b64_tr_b16 v[80:81], v88 offset:31744
  v_mfma_f32_16x16x32_bf16 v[32:35], v[68:71], v[224:227], v[32:35]
  ds_read_b64_tr_b16 v[82:83], v89 offset:31744
  ds_read_b128 v[244:247], v125 offset:10240
  v_mfma_f32_16x16x32_bf16 v[48:51], v[224:227], v[72:75], v[48:51]
  ds_read_b64_tr_b16 v[84:85], v88 offset:48128
  ds_read_b64_tr_b16 v[86:87], v89 offset:48128
  v_mfma_f32_16x16x32_bf16 v[20:23], v[64:67], v[228:231], v[20:23]
  ds_read_b128 v[248:251], v125 offset:12288
  ds_read_b128 v[252:255], v125 offset:14336
  v_mfma_f32_16x16x32_bf16 v[36:39], v[68:71], v[228:231], v[36:39]
  v_mfma_f32_16x16x32_bf16 v[52:55], v[228:231], v[72:75], v[52:55]
  v_mfma_f32_16x16x32_bf16 v[24:27], v[64:67], v[232:235], v[24:27]
  v_mfma_f32_16x16x32_bf16 v[40:43], v[68:71], v[232:235], v[40:43]
  v_mfma_f32_16x16x32_bf16 v[56:59], v[232:235], v[72:75], v[56:59]
  v_mfma_f32_16x16x32_bf16 v[28:31], v[64:67], v[236:239], v[28:31]
  v_mfma_f32_16x16x32_bf16 v[44:47], v[68:71], v[236:239], v[44:47]
  v_mfma_f32_16x16x32_bf16 v[60:63], v[236:239], v[72:75], v[60:63]
  s_waitcnt lgkmcnt(0)
  v_mfma_f32_16x16x32_bf16 v[16:19], v[76:79], v[240:243], v[16:19]
  v_mfma_f32_16x16x32_bf16 v[32:35], v[80:83], v[240:243], v[32:35]
  v_mfma_f32_16x16x32_bf16 v[48:51], v[240:243], v[84:87], v[48:51]
  v_mfma_f32_16x16x32_bf16 v[20:23], v[76:79], v[244:247], v[20:23]
  v_mfma_f32_16x16x32_bf16 v[36:39], v[80:83], v[244:247], v[36:39]
  v_mfma_f32_16x16x32_bf16 v[52:55], v[244:247], v[84:87], v[52:55]
  v_mfma_f32_16x16x32_bf16 v[24:27], v[76:79], v[248:251], v[24:27]
  v_mfma_f32_16x16x32_bf16 v[40:43], v[80:83], v[248:251], v[40:43]
  v_mfma_f32_16x16x32_bf16 v[56:59], v[248:251], v[84:87], v[56:59]
  v_mfma_f32_16x16x32_bf16 v[28:31], v[76:79], v[252:255], v[28:31]
  v_mfma_f32_16x16x32_bf16 v[44:47], v[80:83], v[252:255], v[44:47]
  v_mfma_f32_16x16x32_bf16 v[60:63], v[252:255], v[84:87], v[60:63]
  s_barrier
  v_lshrrev_b32 v90, 4, v1
  v_lshlrev_b32 v91, 4, v90
  v_add_u32 v93, 157696, v91
  v_and_b32 v94, 15, v1
  v_lshlrev_b32 v94, 2, v94
  s_lshl_b32 s84, s3, 8
  s_add_u32 s84, s84, 158208
  v_add_u32 v95, s84, v94
  ds_read_b128 v[136:139], v93 offset:64
  ds_read_b128 v[140:143], v93 offset:256
  ds_read_b32 v146, v95 offset:0
  ds_read_b32 v147, v95 offset:1024
  ds_read_b32 v148, v95 offset:64
  ds_read_b32 v149, v95 offset:1088
  ds_read_b32 v150, v95 offset:128
  ds_read_b32 v151, v95 offset:1152
  ds_read_b32 v152, v95 offset:192
  ds_read_b32 v153, v95 offset:1216
  v_add_u32 v97, 157696, v94
  ds_read_b32 v144, v97 offset:128
  ds_read_b32 v145, v97 offset:320
  v_add_u32 v96, s84, v91
  s_waitcnt lgkmcnt(2)
  ds_read_b128 v[154:157], v96 offset:0
  ds_read_b128 v[158:161], v96 offset:1024
  ds_read_b128 v[162:165], v96 offset:64
  ds_read_b128 v[166:169], v96 offset:1088
  ds_read_b128 v[170:173], v96 offset:128
  ds_read_b128 v[174:177], v96 offset:1152
  ds_read_b128 v[178:181], v96 offset:192
  ds_read_b128 v[182:185], v96 offset:1216
  ds_read_b128 v[128:131], v93
  ds_read_b128 v[132:135], v93 offset:192
  v_lshlrev_b32 v90, 4, v1
  s_lshl_b32 s84, s81, 3
  s_add_u32 s84, s84, s80
  s_lshl_b32 s84, s84, 14
  s_lshl_b32 s85, s3, 11
  s_add_u32 s84, s84, s85
  s_add_u32 s84, s84, 1048576
  s_add_u32 s86, s84, 8192
  v_add_u32 v91, s85, v90
  v_pk_fma_f32 v[186:187], v[146:147], v[136:137], v[140:141] op_sel:[1,0,0] op_sel_hi:[1,1,1]
  v_pk_fma_f32 v[188:189], v[146:147], v[138:139], v[142:143] op_sel:[1,0,0] op_sel_hi:[1,1,1]
  v_pk_fma_f32 v[190:191], v[148:149], v[136:137], v[140:141] op_sel:[1,0,0] op_sel_hi:[1,1,1]
  v_pk_fma_f32 v[192:193], v[148:149], v[138:139], v[142:143] op_sel:[1,0,0] op_sel_hi:[1,1,1]
  v_pk_fma_f32 v[194:195], v[150:151], v[136:137], v[140:141] op_sel:[1,0,0] op_sel_hi:[1,1,1]
  v_pk_fma_f32 v[196:197], v[150:151], v[138:139], v[142:143] op_sel:[1,0,0] op_sel_hi:[1,1,1]
  v_pk_fma_f32 v[198:199], v[152:153], v[136:137], v[140:141] op_sel:[1,0,0] op_sel_hi:[1,1,1]
  v_pk_fma_f32 v[200:201], v[152:153], v[138:139], v[142:143] op_sel:[1,0,0] op_sel_hi:[1,1,1]
  v_pk_fma_f32 v[32:33], v[32:33], v[146:147], v[186:187] op_sel:[0,0,0] op_sel_hi:[1,0,1]
  v_pk_fma_f32 v[34:35], v[34:35], v[146:147], v[188:189] op_sel:[0,0,0] op_sel_hi:[1,0,1]
  v_pk_fma_f32 v[36:37], v[36:37], v[148:149], v[190:191] op_sel:[0,0,0] op_sel_hi:[1,0,1]
  v_pk_fma_f32 v[38:39], v[38:39], v[148:149], v[192:193] op_sel:[0,0,0] op_sel_hi:[1,0,1]
  v_pk_fma_f32 v[40:41], v[40:41], v[150:151], v[194:195] op_sel:[0,0,0] op_sel_hi:[1,0,1]
  v_pk_fma_f32 v[42:43], v[42:43], v[150:151], v[196:197] op_sel:[0,0,0] op_sel_hi:[1,0,1]
  v_pk_fma_f32 v[44:45], v[44:45], v[152:153], v[198:199] op_sel:[0,0,0] op_sel_hi:[1,0,1]
  v_pk_fma_f32 v[46:47], v[46:47], v[152:153], v[200:201] op_sel:[0,0,0] op_sel_hi:[1,0,1]
  v_cvt_pk_bf16_f32 v64, v32, v33
  v_cvt_pk_bf16_f32 v65, v34, v35
  v_cvt_pk_bf16_f32 v66, v36, v37
  v_cvt_pk_bf16_f32 v67, v38, v39
  v_cvt_pk_bf16_f32 v68, v40, v41
  v_cvt_pk_bf16_f32 v69, v42, v43
  v_cvt_pk_bf16_f32 v70, v44, v45
  v_cvt_pk_bf16_f32 v71, v46, v47
  v_permlane16_swap_b32 v64, v66
  v_permlane16_swap_b32 v68, v70
  v_permlane16_swap_b32 v65, v67
  v_permlane16_swap_b32 v69, v71
  buffer_store_dwordx4 v[64:67], v90, s[76:79], s84 offen offset:0 sc1
  buffer_store_dwordx4 v[68:71], v90, s[76:79], s84 offen offset:1024 sc1
  ds_write_b128 v91, v[64:67] offset:0
  ds_write_b128 v91, v[68:71] offset:1024
  s_waitcnt lgkmcnt(4)
  v_pk_fma_f32 v[186:187], v[158:159], v[144:145], v[144:145] op_sel:[0,0,1] op_sel_hi:[1,0,1]
  v_pk_fma_f32 v[188:189], v[160:161], v[144:145], v[144:145] op_sel:[0,0,1] op_sel_hi:[1,0,1]
  v_pk_fma_f32 v[190:191], v[166:167], v[144:145], v[144:145] op_sel:[0,0,1] op_sel_hi:[1,0,1]
  v_pk_fma_f32 v[192:193], v[168:169], v[144:145], v[144:145] op_sel:[0,0,1] op_sel_hi:[1,0,1]
  v_pk_fma_f32 v[194:195], v[174:175], v[144:145], v[144:145] op_sel:[0,0,1] op_sel_hi:[1,0,1]
  v_pk_fma_f32 v[196:197], v[176:177], v[144:145], v[144:145] op_sel:[0,0,1] op_sel_hi:[1,0,1]
  v_pk_fma_f32 v[198:199], v[182:183], v[144:145], v[144:145] op_sel:[0,0,1] op_sel_hi:[1,0,1]
  v_pk_fma_f32 v[200:201], v[184:185], v[144:145], v[144:145] op_sel:[0,0,1] op_sel_hi:[1,0,1]
  v_pk_fma_f32 v[48:49], v[48:49], v[154:155], v[186:187]
  v_pk_fma_f32 v[50:51], v[50:51], v[156:157], v[188:189]
  v_pk_fma_f32 v[52:53], v[52:53], v[162:163], v[190:191]
  v_pk_fma_f32 v[54:55], v[54:55], v[164:165], v[192:193]
  v_pk_fma_f32 v[56:57], v[56:57], v[170:171], v[194:195]
  v_pk_fma_f32 v[58:59], v[58:59], v[172:173], v[196:197]
  v_pk_fma_f32 v[60:61], v[60:61], v[178:179], v[198:199]
  v_pk_fma_f32 v[62:63], v[62:63], v[180:181], v[200:201]
  v_cvt_pk_bf16_f32 v72, v48, v49
  v_cvt_pk_bf16_f32 v73, v50, v51
  v_cvt_pk_bf16_f32 v74, v52, v53
  v_cvt_pk_bf16_f32 v75, v54, v55
  v_cvt_pk_bf16_f32 v76, v56, v57
  v_cvt_pk_bf16_f32 v77, v58, v59
  v_cvt_pk_bf16_f32 v78, v60, v61
  v_cvt_pk_bf16_f32 v79, v62, v63
  v_dot2_f32_bf16 v202, v64, v64, 0
  v_dot2_f32_bf16 v206, v68, v68, 0
  v_dot2_f32_bf16 v202, v65, v65, v202
  v_dot2_f32_bf16 v206, v69, v69, v206
  v_dot2_f32_bf16 v202, v66, v66, v202
  v_dot2_f32_bf16 v206, v70, v70, v206
  v_dot2_f32_bf16 v202, v67, v67, v202
  v_dot2_f32_bf16 v206, v71, v71, v206
  v_permlane16_swap_b32 v72, v74
  v_permlane16_swap_b32 v76, v78
  v_permlane16_swap_b32 v73, v75
  v_permlane16_swap_b32 v77, v79
  buffer_store_dwordx4 v[72:75], v90, s[76:79], s86 offen offset:0 sc1
  buffer_store_dwordx4 v[76:79], v90, s[76:79], s86 offen offset:1024 sc1
  ds_write_b128 v91, v[72:75] offset:8192
  ds_write_b128 v91, v[76:79] offset:9216
  s_waitcnt lgkmcnt(4)
  v_pk_fma_f32 v[186:187], v[146:147], v[128:129], v[132:133] op_sel:[1,0,0] op_sel_hi:[1,1,1]
  v_pk_fma_f32 v[188:189], v[146:147], v[130:131], v[134:135] op_sel:[1,0,0] op_sel_hi:[1,1,1]
  v_pk_fma_f32 v[190:191], v[148:149], v[128:129], v[132:133] op_sel:[1,0,0] op_sel_hi:[1,1,1]
  v_pk_fma_f32 v[192:193], v[148:149], v[130:131], v[134:135] op_sel:[1,0,0] op_sel_hi:[1,1,1]
  v_pk_fma_f32 v[194:195], v[150:151], v[128:129], v[132:133] op_sel:[1,0,0] op_sel_hi:[1,1,1]
  v_pk_fma_f32 v[196:197], v[150:151], v[130:131], v[134:135] op_sel:[1,0,0] op_sel_hi:[1,1,1]
  v_pk_fma_f32 v[198:199], v[152:153], v[128:129], v[132:133] op_sel:[1,0,0] op_sel_hi:[1,1,1]
  v_pk_fma_f32 v[200:201], v[152:153], v[130:131], v[134:135] op_sel:[1,0,0] op_sel_hi:[1,1,1]
  v_mov_b32 v210, 0x3eb8aa3b
  v_pk_fma_f32 v[16:17], v[16:17], v[146:147], v[186:187] op_sel:[0,0,0] op_sel_hi:[1,0,1]
  v_pk_fma_f32 v[18:19], v[18:19], v[146:147], v[188:189] op_sel:[0,0,0] op_sel_hi:[1,0,1]
  v_pk_fma_f32 v[20:21], v[20:21], v[148:149], v[190:191] op_sel:[0,0,0] op_sel_hi:[1,0,1]
  v_pk_fma_f32 v[22:23], v[22:23], v[148:149], v[192:193] op_sel:[0,0,0] op_sel_hi:[1,0,1]
  v_pk_fma_f32 v[24:25], v[24:25], v[150:151], v[194:195] op_sel:[0,0,0] op_sel_hi:[1,0,1]
  v_pk_fma_f32 v[26:27], v[26:27], v[150:151], v[196:197] op_sel:[0,0,0] op_sel_hi:[1,0,1]
  v_pk_fma_f32 v[28:29], v[28:29], v[152:153], v[198:199] op_sel:[0,0,0] op_sel_hi:[1,0,1]
  v_pk_fma_f32 v[30:31], v[30:31], v[152:153], v[200:201] op_sel:[0,0,0] op_sel_hi:[1,0,1]
  v_pk_mul_f32 v[16:17], v[16:17], v[210:211] op_sel_hi:[1,0]
  v_pk_mul_f32 v[18:19], v[18:19], v[210:211] op_sel_hi:[1,0]
  v_pk_mul_f32 v[20:21], v[20:21], v[210:211] op_sel_hi:[1,0]
  v_pk_mul_f32 v[22:23], v[22:23], v[210:211] op_sel_hi:[1,0]
  v_pk_mul_f32 v[24:25], v[24:25], v[210:211] op_sel_hi:[1,0]
  v_pk_mul_f32 v[26:27], v[26:27], v[210:211] op_sel_hi:[1,0]
  v_pk_mul_f32 v[28:29], v[28:29], v[210:211] op_sel_hi:[1,0]
  v_pk_mul_f32 v[30:31], v[30:31], v[210:211] op_sel_hi:[1,0]
  v_cvt_pk_bf16_f32 v112, v16, v17
  v_cvt_pk_bf16_f32 v113, v18, v19
  v_cvt_pk_bf16_f32 v114, v20, v21
  v_cvt_pk_bf16_f32 v115, v22, v23
  v_cvt_pk_bf16_f32 v80, v24, v25
  v_cvt_pk_bf16_f32 v81, v26, v27
  v_cvt_pk_bf16_f32 v82, v28, v29
  v_cvt_pk_bf16_f32 v83, v30, v31
  v_permlane16_swap_b32 v112, v114
  v_permlane16_swap_b32 v80, v82
  v_permlane16_swap_b32 v113, v115
  v_permlane16_swap_b32 v81, v83
  s_lshl_b32 s85, s3, 10
  s_add_u32 s85, s85, 149504
  v_add_u32 v92, s85, v90
  ds_write_b128 v92, v[80:83]
  v_dot2_f32_bf16 v204, v112, v112, 0
  v_dot2_f32_bf16 v208, v80, v80, 0
  v_dot2_f32_bf16 v204, v113, v113, v204
  v_dot2_f32_bf16 v208, v81, v81, v208
  v_dot2_f32_bf16 v204, v114, v114, v204
  v_dot2_f32_bf16 v208, v82, v82, v208
  v_dot2_f32_bf16 v204, v115, v115, v204
  v_dot2_f32_bf16 v208, v83, v83, v208
  s_nop 0
  v_permlane32_swap_b32 v202, v204
  v_add_f32 v202, v202, v204
  v_permlane32_swap_b32 v206, v208
  v_add_f32 v206, v206, v208
  v_max_f32_dpp v202, v202, v202 row_shr:1 row_mask:0xf bank_mask:0xf
  s_nop 0
  v_max_f32_dpp v206, v206, v206 row_shr:1 row_mask:0xf bank_mask:0xf
  v_max_f32_dpp v202, v202, v202 row_shr:2 row_mask:0xf bank_mask:0xf
  s_nop 0
  v_max_f32_dpp v206, v206, v206 row_shr:2 row_mask:0xf bank_mask:0xf
  v_max_f32_dpp v202, v202, v202 row_shr:4 row_mask:0xf bank_mask:0xf
  s_nop 0
  v_max_f32_dpp v206, v206, v206 row_shr:4 row_mask:0xf bank_mask:0xf
  v_max_f32_dpp v202, v202, v202 row_shr:8 row_mask:0xf bank_mask:0xf
  s_nop 0
  v_max_f32_dpp v206, v206, v206 row_shr:8 row_mask:0xf bank_mask:0xf
  v_max_f32_dpp v202, v202, v202 row_bcast:15 row_mask:0xa bank_mask:0xf
  s_nop 0
  v_max_f32_dpp v206, v206, v206 row_bcast:15 row_mask:0xa bank_mask:0xf
  v_max_f32 v203, v202, v206
  v_lshrrev_b32 v204, 5, v1
  v_readlane_b32 s91, v203, 31
  v_lshlrev_b32 v204, 5, v204
  s_lshl_b32 s85, s3, 3
  s_add_u32 s85, s85, 160768
  v_add_u32 v204, s85, v204
  s_mov_b32 exec_lo, 0x80000000
  s_mov_b32 exec_hi, 0x80000000
  ds_write_b32 v204, v202
  ds_write_b32 v204, v206 offset:4
  s_mov_b64 exec, -1
  s_waitcnt lgkmcnt(0)
  s_barrier
  s_branch Lp2e_2
Lloader_1:
  s_cmp_lt_u32 s98, 2
  s_cbranch_scc0 Lnp_8
  s_mov_b32 s64, s24
  s_and_b32 s65, s25, 0xffff
  s_mov_b32 s66, 0x00000400
  s_mov_b32 s67, 0x00020000
  s_mov_b32 s68, s26
  s_and_b32 s69, s27, 0xffff
  s_mov_b32 s70, 0x00300000
  s_mov_b32 s71, 0x00020000
  s_mul_i32 s84, s3, 256
  buffer_load_ushort v176, v92, s[64:67], s84 offen offset:0
  buffer_load_ushort v177, v92, s[64:67], s84 offen offset:64
  buffer_load_ushort v178, v92, s[64:67], s84 offen offset:128
  buffer_load_ushort v179, v92, s[64:67], s84 offen offset:192
  s_lshl_b32 s85, s98, 5
  s_add_u32 s85, s85, s99
  s_lshl_b32 s85, s85, 5
  s_mul_i32 s84, s3, 786432
  s_add_u32 s84, s84, s85
  buffer_load_dwordx4 v[128:131], v91, s[68:71], s84 offen
  s_add_u32 s84, s84, 196608
  buffer_load_dwordx4 v[132:135], v91, s[68:71], s84 offen
  s_add_u32 s84, s84, 196608
  buffer_load_dwordx4 v[136:139], v91, s[68:71], s84 offen
  s_add_u32 s84, s84, 196608
  buffer_load_dwordx4 v[140:143], v91, s[68:71], s84 offen
  s_mov_b32 s40, s10
  s_and_b32 s41, s11, 0xffff
  s_mov_b32 s42, 0x00180000
  s_mov_b32 s43, 0x00020000
  s_branch Lnp_9
Lnp_8:
  s_mov_b32 s40, s10
  s_and_b32 s41, s11, 0xffff
  s_mov_b32 s42, 0x00180000
  s_mov_b32 s43, 0x00020000
  s_cmp_lg_u32 s82, 4
  s_cbranch_scc1 Lnt_10
  s_mul_i32 s84, s99, 48
  v_add_u32 v104, s84, v1
  v_mul_u32_u24 v105, 21846, v104
  v_lshrrev_b32 v105, 16, v105
  v_mul_u32_u24 v106, 3, v105
  v_sub_u32 v106, v104, v106
  v_mul_u32_u24 v105, 3072, v105
  v_lshl_add_u32 v105, v106, 10, v105
  s_lshr_b32 s84, s98, 1
  s_lshl_b32 s84, s84, 8
  s_mov_b32 exec_lo, 0xffffffff
  s_mov_b32 exec_hi, 0x0000ffff
  buffer_load_dword v7, v105, s[40:43], s84 offen offset:0
  buffer_load_dword v7, v105, s[40:43], s84 offen offset:128
  s_mov_b64 exec, -1
Lnt_10:
  s_mov_b32 s64, s24
  s_and_b32 s65, s25, 0xffff
  s_mov_b32 s66, 0x00000400
  s_mov_b32 s67, 0x00020000
  s_mov_b32 s68, s26
  s_and_b32 s69, s27, 0xffff
  s_mov_b32 s70, 0x00300000
  s_mov_b32 s71, 0x00020000
Lnp_9:
  s_mov_b32 s36, s8
  s_and_b32 s37, s9, 0xffff
  s_mov_b32 s38, 0x00200000
  s_mov_b32 s39, 0x00020000
  buffer_load_dwordx4 v[16:19], v100, s[36:39], s88 offen offset:0
  buffer_load_dwordx4 v[20:23], v100, s[36:39], s88 offen offset:1024
  v_lshrrev_b32 v96, 3, v1
  v_lshlrev_b32 v96, 10, v96
  v_lshrrev_b32 v97, 4, v1
  v_and_b32 v98, 7, v1
  v_xor_b32 v99, v98, v97
  v_lshl_add_u32 v94, v99, 4, v96
  v_xor_b32 v99, 4, v99
  v_lshl_add_u32 v95, v99, 4, v96
  s_lshl_b32 s84, s80, 2
  s_add_u32 s84, s84, s3
  s_lshl_b32 s10, s84, 16
  s_mul_i32 s11, s3, 24576
  s_cmp_lt_u32 s98, 2
  s_cbranch_scc1 Lnx_11
  s_add_u32 s84, s6, 0
  s_and_b32 s84, s84, 7
  s_lshl_b32 s84, s84, 7
  s_add_u32 s84, s84, s10
  s_add_u32 m0, s11, 0
  s_nop 0
  buffer_load_dwordx4 v94, s[36:39], s84 offen lds
  s_add_u32 m0, s11, 1024
  s_add_u32 s84, s84, 8192
  buffer_load_dwordx4 v95, s[36:39], s84 offen lds
  s_add_u32 m0, s11, 2048
  s_add_u32 s84, s84, 8192
  buffer_load_dwordx4 v94, s[36:39], s84 offen lds
  s_add_u32 m0, s11, 3072
  s_add_u32 s84, s84, 8192
  buffer_load_dwordx4 v95, s[36:39], s84 offen lds
  s_add_u32 m0, s11, 4096
  s_add_u32 s84, s84, 8192
  buffer_load_dwordx4 v94, s[36:39], s84 offen lds
  s_add_u32 m0, s11, 5120
  s_add_u32 s84, s84, 8192
  buffer_load_dwordx4 v95, s[36:39], s84 offen lds
  s_add_u32 m0, s11, 6144
  s_add_u32 s84, s84, 8192
  buffer_load_dwordx4 v94, s[36:39], s84 offen lds
  s_add_u32 m0, s11, 7168
  s_add_u32 s84, s84, 8192
  buffer_load_dwordx4 v95, s[36:39], s84 offen lds
Lnx_11:
  s_barrier
  s_mov_b32 s76, s32
  s_and_b32 s77, s33, 0xffff
  s_mov_b32 s78, 0x01000000
  s_mov_b32 s79, 0x00020000
  s_mov_b32 s44, s12
  s_and_b32 s45, s13, 0xffff
  s_mov_b32 s46, 0x00080000
  s_mov_b32 s47, 0x00020000
  s_mov_b32 s48, s16
  s_and_b32 s49, s17, 0xffff
  s_mov_b32 s50, 0x00000400
  s_mov_b32 s51, 0x00020000
  s_mov_b32 s52, s18
  s_and_b32 s53, s19, 0xffff
  s_mov_b32 s54, 0x001c0000
  s_mov_b32 s55, 0x00020000
  s_mov_b32 s56, s20
  s_and_b32 s57, s21, 0xffff
  s_mov_b32 s58, 0x001c0000
  s_mov_b32 s59, 0x00020000
  s_mov_b32 s60, s22
  s_and_b32 s61, s23, 0xffff
  s_mov_b32 s62, 0x001c0000
  s_mov_b32 s63, 0x00020000
  s_mov_b32 s72, s28
  s_and_b32 s73, s29, 0xffff
  s_mov_b32 s74, 0x00200000
  s_mov_b32 s75, 0x00020000
  s_waitcnt lgkmcnt(0)
  s_mul_i32 s83, s83, 0x9E3779B1
  s_add_u32 s83, s83, 0x7F4A7C15
  s_cmp_lt_u32 s98, 2
  s_cbranch_scc0 Lnp_12
  s_waitcnt vmcnt(6)
  v_lshlrev_b32 v176, 16, v176
  v_lshlrev_b32 v177, 16, v177
  v_lshlrev_b32 v178, 16, v178
  v_lshlrev_b32 v179, 16, v179
  v_mul_f32 v48, 0xbfb8aa3b, v176
  v_mul_f32 v49, 0xbfb8aa3b, v177
  v_mul_f32 v50, 0xbfb8aa3b, v178
  v_mul_f32 v51, 0xbfb8aa3b, v179
  v_exp_f32 v48, v48
  v_exp_f32 v49, v49
  v_exp_f32 v50, v50
  v_exp_f32 v51, v51
  v_add_f32 v48, 1.0, v48
  v_add_f32 v49, 1.0, v49
  v_add_f32 v50, 1.0, v50
  v_add_f32 v51, 1.0, v51
  v_rcp_f32 v48, v48
  v_rcp_f32 v49, v49
  v_rcp_f32 v50, v50
  v_rcp_f32 v51, v51
  v_mul_f32 v176, v176, v48
  v_mul_f32 v177, v177, v49
  v_mul_f32 v178, v178, v50
  v_mul_f32 v179, v179, v51
  s_waitcnt vmcnt(5)
  v_lshlrev_b32 v40, 16, v128
  v_and_b32 v41, 0xffff0000, v128
  v_lshlrev_b32 v42, 16, v129
  v_and_b32 v43, 0xffff0000, v129
  v_lshlrev_b32 v44, 16, v130
  v_and_b32 v45, 0xffff0000, v130
  v_lshlrev_b32 v46, 16, v131
  v_and_b32 v47, 0xffff0000, v131
  v_mul_f32 v40, v176, v40
  v_mul_f32 v41, v176, v41
  v_mul_f32 v42, v176, v42
  v_mul_f32 v43, v176, v43
  v_mul_f32 v44, v176, v44
  v_mul_f32 v45, v176, v45
  v_mul_f32 v46, v176, v46
  v_mul_f32 v47, v176, v47
  s_waitcnt vmcnt(4)
  v_lshlrev_b32 v48, 16, v132
  v_and_b32 v49, 0xffff0000, v132
  v_lshlrev_b32 v50, 16, v133
  v_and_b32 v51, 0xffff0000, v133
  v_lshlrev_b32 v52, 16, v134
  v_and_b32 v53, 0xffff0000, v134
  v_lshlrev_b32 v54, 16, v135
  v_and_b32 v55, 0xffff0000, v135
  v_fmac_f32 v40, v177, v48
  v_fmac_f32 v41, v177, v49
  v_fmac_f32 v42, v177, v50
  v_fmac_f32 v43, v177, v51
  v_fmac_f32 v44, v177, v52
  v_fmac_f32 v45, v177, v53
  v_fmac_f32 v46, v177, v54
  v_fmac_f32 v47, v177, v55
  s_waitcnt vmcnt(3)
  v_lshlrev_b32 v48, 16, v136
  v_and_b32 v49, 0xffff0000, v136
  v_lshlrev_b32 v50, 16, v137
  v_and_b32 v51, 0xffff0000, v137
  v_lshlrev_b32 v52, 16, v138
  v_and_b32 v53, 0xffff0000, v138
  v_lshlrev_b32 v54, 16, v139
  v_and_b32 v55, 0xffff0000, v139
  v_fmac_f32 v40, v178, v48
  v_fmac_f32 v41, v178, v49
  v_fmac_f32 v42, v178, v50
  v_fmac_f32 v43, v178, v51
  v_fmac_f32 v44, v178, v52
  v_fmac_f32 v45, v178, v53
  v_fmac_f32 v46, v178, v54
  v_fmac_f32 v47, v178, v55
  s_waitcnt vmcnt(2)
  v_lshlrev_b32 v48, 16, v140
  v_and_b32 v49, 0xffff0000, v140
  v_lshlrev_b32 v50, 16, v141
  v_and_b32 v51, 0xffff0000, v141
  v_lshlrev_b32 v52, 16, v142
  v_and_b32 v53, 0xffff0000, v142
  v_lshlrev_b32 v54, 16, v143
  v_and_b32 v55, 0xffff0000, v143
  v_fmac_f32 v40, v179, v48
  v_fmac_f32 v41, v179, v49
  v_fmac_f32 v42, v179, v50
  v_fmac_f32 v43, v179, v51
  v_fmac_f32 v44, v179, v52
  v_fmac_f32 v45, v179, v53
  v_fmac_f32 v46, v179, v54
  v_fmac_f32 v47, v179, v55
  v_permlane32_swap_b32 v40, v41
  v_add_f32 v40, v40, v41
  v_permlane32_swap_b32 v42, v43
  v_add_f32 v42, v42, v43
  v_permlane32_swap_b32 v44, v45
  v_add_f32 v44, v44, v45
  v_permlane32_swap_b32 v46, v47
  v_add_f32 v46, v46, v47
  v_permlane16_swap_b32 v40, v42
  v_add_f32 v40, v40, v42
  v_permlane16_swap_b32 v44, v46
  v_add_f32 v44, v44, v46
  v_add_f32_dpp v40, v40, v40 row_shr:2 row_mask:0xf bank_mask:0xf
  s_nop 0
  v_add_f32_dpp v44, v44, v44 row_shr:2 row_mask:0xf bank_mask:0xf
  v_add_f32_dpp v40, v40, v40 row_shr:4 row_mask:0xf bank_mask:0xf
  s_nop 0
  v_add_f32_dpp v44, v44, v44 row_shr:4 row_mask:0xf bank_mask:0xf
  v_add_f32_dpp v40, v40, v40 row_shr:8 row_mask:0xf bank_mask:0xf
  s_nop 0
  v_add_f32_dpp v44, v44, v44 row_shr:8 row_mask:0xf bank_mask:0xf
  v_lshrrev_b32 v48, 4, v1
  v_and_b32 v49, 1, v48
  v_lshlrev_b32 v49, 1, v49
  v_lshrrev_b32 v48, 1, v48
  v_or_b32 v48, v48, v49
  v_and_b32 v49, 1, v1
  v_lshl_add_u32 v48, v49, 3, v48
  s_lshl_b32 s85, s3, 6
  s_add_u32 s85, s85, 160256
  v_lshl_add_u32 v48, v48, 2, s85
  s_mov_b32 exec_lo, 0xc000c000
  s_mov_b32 exec_hi, 0xc000c000
  ds_write_b32 v48, v40
  ds_write_b32 v48, v44 offset:16
  s_mov_b64 exec, -1
  v_mov_b32 v48, 160832
  v_mov_b32 v49, 1
  s_mov_b32 exec_lo, 0x00000001
  s_mov_b32 exec_hi, 0x00000000
  ds_add_rtn_u32 v49, v48, v49
  s_waitcnt lgkmcnt(0)
  s_mov_b64 exec, -1
  v_readfirstlane_b32 s84, v49
  s_nop 0
  s_cmp_lg_u32 s84, 3
  s_cbranch_scc1 Lnl_15
  v_and_b32 v48, 15, v1
  v_lshlrev_b32 v49, 2, v48
  v_add_u32 v49, 160256, v49
  ds_read_b32 v40, v49 offset:0
  ds_read_b32 v41, v49 offset:64
  ds_read_b32 v42, v49 offset:128
  ds_read_b32 v43, v49 offset:192
  v_lshlrev_b32 v48, 3, v48
  s_lshl_b32 s84, s98, 5
  s_add_u32 s84, s84, s99
  s_lshl_b32 s84, s84, 7
  s_add_u32 s84, s84, 4096
  v_mov_b32 v49, s83
  s_waitcnt lgkmcnt(0)
  v_add_f32 v40, v40, v41
  v_add_f32 v42, v42, v43
  v_add_f32 v40, v40, v42
  v_mov_b32 v41, v49
  s_mov_b32 exec_lo, 0x0000ffff
  s_mov_b32 exec_hi, 0x00000000
  buffer_store_dwordx2 v[40:41], v48, s[76:79], s84 offen sc1
  s_mov_b64 exec, -1
  s_waitcnt vmcnt(1)
  s_branch Lrel_14
Lnl_15:
  s_waitcnt vmcnt(0)
Lrel_14:
  s_barrier
  s_branch Lstat_13
Lnp_12:
  s_waitcnt vmcnt(8)
Lstat_13:
  v_lshlrev_b32 v56, 16, v16
  v_and_b32 v57, 0xffff0000, v16
  v_lshlrev_b32 v58, 16, v17
  v_and_b32 v59, 0xffff0000, v17
  v_lshlrev_b32 v60, 16, v18
  v_and_b32 v61, 0xffff0000, v18
  v_lshlrev_b32 v62, 16, v19
  v_and_b32 v63, 0xffff0000, v19
  v_lshlrev_b32 v64, 16, v20
  v_and_b32 v65, 0xffff0000, v20
  v_lshlrev_b32 v66, 16, v21
  v_and_b32 v67, 0xffff0000, v21
  v_lshlrev_b32 v68, 16, v22
  v_and_b32 v69, 0xffff0000, v22
  v_lshlrev_b32 v70, 16, v23
  v_and_b32 v71, 0xffff0000, v23
  v_add_f32 v72, v56, v57
  v_add_f32 v80, v64, v65
  v_add_f32 v72, v72, v58
  v_add_f32 v80, v80, v66
  v_add_f32 v72, v72, v59
  v_add_f32 v80, v80, v67
  v_add_f32 v72, v72, v60
  v_add_f32 v80, v80, v68
  v_add_f32 v72, v72, v61
  v_add_f32 v80, v80, v69
  v_add_f32 v72, v72, v62
  v_add_f32 v80, v80, v70
  v_add_f32 v72, v72, v63
  v_add_f32 v80, v80, v71
  s_nop 0
  v_add_f32_dpp v72, v72, v72 row_shr:1 row_mask:0xf bank_mask:0xf
  v_add_f32_dpp v80, v80, v80 row_shr:1 row_mask:0xf bank_mask:0xf
  s_nop 0
  v_add_f32_dpp v72, v72, v72 row_shr:2 row_mask:0xf bank_mask:0xf
  v_add_f32_dpp v80, v80, v80 row_shr:2 row_mask:0xf bank_mask:0xf
  s_nop 0
  v_add_f32_dpp v72, v72, v72 row_shr:4 row_mask:0xf bank_mask:0xf
  v_add_f32_dpp v80, v80, v80 row_shr:4 row_mask:0xf bank_mask:0xf
  s_nop 0
  v_add_f32_dpp v72, v72, v72 row_shr:8 row_mask:0xf bank_mask:0xf
  v_add_f32_dpp v80, v80, v80 row_shr:8 row_mask:0xf bank_mask:0xf
  s_nop 0
  v_add_f32_dpp v72, v72, v72 row_bcast:15 row_mask:0xa bank_mask:0xf
  v_add_f32_dpp v80, v80, v80 row_bcast:15 row_mask:0xa bank_mask:0xf
  s_nop 0
  v_add_f32_dpp v72, v72, v72 row_bcast:31 row_mask:0xc bank_mask:0xf
  v_add_f32_dpp v80, v80, v80 row_bcast:31 row_mask:0xc bank_mask:0xf
  v_readlane_b32 s84, v72, 63
  v_readlane_b32 s85, v80, 63
  v_mov_b32 v74, 0x3b000000
  v_mov_b32 v75, 0x3727c5ac
  v_mul_f32 v76, s84, v74
  v_mul_f32 v84, s85, v74
  v_sub_f32 v56, v56, v76
  v_sub_f32 v64, v64, v84
  v_sub_f32 v57, v57, v76
  v_sub_f32 v65, v65, v84
  v_sub_f32 v58, v58, v76
  v_sub_f32 v66, v66, v84
  v_sub_f32 v59, v59, v76
  v_sub_f32 v67, v67, v84
  v_sub_f32 v60, v60, v76
  v_sub_f32 v68, v68, v84
  v_sub_f32 v61, v61, v76
  v_sub_f32 v69, v69, v84
  v_sub_f32 v62, v62, v76
  v_sub_f32 v70, v70, v84
  v_sub_f32 v63, v63, v76
  v_sub_f32 v71, v71, v84
  v_mul_f32 v72, v56, v56
  v_mul_f32 v80, v64, v64
  v_fmac_f32 v72, v57, v57
  v_fmac_f32 v80, v65, v65
  v_fmac_f32 v72, v58, v58
  v_fmac_f32 v80, v66, v66
  v_fmac_f32 v72, v59, v59
  v_fmac_f32 v80, v67, v67
  v_fmac_f32 v72, v60, v60
  v_fmac_f32 v80, v68, v68
  v_fmac_f32 v72, v61, v61
  v_fmac_f32 v80, v69, v69
  v_fmac_f32 v72, v62, v62
  v_fmac_f32 v80, v70, v70
  v_fmac_f32 v72, v63, v63
  v_fmac_f32 v80, v71, v71
  s_nop 0
  v_add_f32_dpp v72, v72, v72 row_shr:1 row_mask:0xf bank_mask:0xf
  v_add_f32_dpp v80, v80, v80 row_shr:1 row_mask:0xf bank_mask:0xf
  s_nop 0
  v_add_f32_dpp v72, v72, v72 row_shr:2 row_mask:0xf bank_mask:0xf
  v_add_f32_dpp v80, v80, v80 row_shr:2 row_mask:0xf bank_mask:0xf
  s_nop 0
  v_add_f32_dpp v72, v72, v72 row_shr:4 row_mask:0xf bank_mask:0xf
  v_add_f32_dpp v80, v80, v80 row_shr:4 row_mask:0xf bank_mask:0xf
  s_nop 0
  v_add_f32_dpp v72, v72, v72 row_shr:8 row_mask:0xf bank_mask:0xf
  v_add_f32_dpp v80, v80, v80 row_shr:8 row_mask:0xf bank_mask:0xf
  s_nop 0
  v_add_f32_dpp v72, v72, v72 row_bcast:15 row_mask:0xa bank_mask:0xf
  v_add_f32_dpp v80, v80, v80 row_bcast:15 row_mask:0xa bank_mask:0xf
  s_nop 0
  v_add_f32_dpp v72, v72, v72 row_bcast:31 row_mask:0xc bank_mask:0xf
  v_add_f32_dpp v80, v80, v80 row_bcast:31 row_mask:0xc bank_mask:0xf
  v_fma_f32 v72, v72, v74, v75
  v_fma_f32 v80, v80, v74, v75
  v_rsq_f32 v77, v72
  v_rsq_f32 v85, v80
  v_mov_b32 v78, s83
  v_mov_b32 v79, 0
  v_readlane_b32 s84, v84, 63
  v_readlane_b32 s85, v85, 63
  v_sub_u32 v73, 63, v1
  v_lshlrev_b32 v73, 4, v73
  s_nop 0
  v_writelane_b32 v76, s84, 62
  v_writelane_b32 v77, s85, 62
  s_lshl_b32 s84, s90, 7
  s_lshl_b32 s85, s3, 5
  s_add_u32 s84, s84, s85
  s_add_u32 s84, s84, 32768
  s_mov_b32 exec_lo, 0x00000000
  s_mov_b32 exec_hi, 0xc0000000
  buffer_store_dwordx4 v[76:79], v73, s[76:79], s84 offen sc1
  s_mov_b64 exec, -1
  s_barrier
  s_cmp_lt_u32 s98, 2
  s_cbranch_scc1 Lx_16
  s_sub_u32 s84, s98, 2
  s_cmp_lt_u32 s84, 4
  s_cbranch_scc0 Lmt_18
  s_sub_u32 s84, s82, 5
  s_cmp_ge_u32 s84, 2
  s_cbranch_scc1 Lmt_18
  s_and_b32 s85, s99, 3
  s_lshl_b32 s85, s85, 1
  s_add_u32 s84, s84, s85
  s_lshl_b32 s84, s84, 6
  v_add_u32 v24, s84, v1
  v_mul_u32_u24 v24, 6144, v24
  s_lshl_b32 s84, s98, 5
  s_add_u32 s84, s84, s99
  s_lshr_b32 s84, s84, 2
  s_lshl_b32 s84, s84, 7
  buffer_load_dword v7, v24, s[68:71], s84 offen
Lmt_18:
  s_add_u32 s84, s6, 1
  s_and_b32 s84, s84, 7
  s_lshl_b32 s84, s84, 7
  s_add_u32 s84, s84, s10
  s_add_u32 m0, s11, 8192
  s_nop 0
  buffer_load_dwordx4 v94, s[36:39], s84 offen lds
  s_add_u32 m0, s11, 9216
  s_add_u32 s84, s84, 8192
  buffer_load_dwordx4 v95, s[36:39], s84 offen lds
  s_add_u32 m0, s11, 10240
  s_add_u32 s84, s84, 8192
  buffer_load_dwordx4 v94, s[36:39], s84 offen lds
  s_add_u32 m0, s11, 11264
  s_add_u32 s84, s84, 8192
  buffer_load_dwordx4 v95, s[36:39], s84 offen lds
  s_add_u32 m0, s11, 12288
  s_add_u32 s84, s84, 8192
  buffer_load_dwordx4 v94, s[36:39], s84 offen lds
  s_add_u32 m0, s11, 13312
  s_add_u32 s84, s84, 8192
  buffer_load_dwordx4 v95, s[36:39], s84 offen lds
  s_add_u32 m0, s11, 14336
  s_add_u32 s84, s84, 8192
  buffer_load_dwordx4 v94, s[36:39], s84 offen lds
  s_add_u32 m0, s11, 15360
  s_add_u32 s84, s84, 8192
  buffer_load_dwordx4 v95, s[36:39], s84 offen lds
  s_add_u32 s84, s6, 2
  s_and_b32 s84, s84, 7
  s_lshl_b32 s84, s84, 7
  s_add_u32 s84, s84, s10
  s_add_u32 m0, s11, 16384
  s_nop 0
  buffer_load_dwordx4 v94, s[36:39], s84 offen lds
  s_add_u32 m0, s11, 17408
  s_add_u32 s84, s84, 8192
  buffer_load_dwordx4 v95, s[36:39], s84 offen lds
  s_add_u32 m0, s11, 18432
  s_add_u32 s84, s84, 8192
  buffer_load_dwordx4 v94, s[36:39], s84 offen lds
  s_add_u32 m0, s11, 19456
  s_add_u32 s84, s84, 8192
  buffer_load_dwordx4 v95, s[36:39], s84 offen lds
  s_add_u32 m0, s11, 20480
  s_add_u32 s84, s84, 8192
  buffer_load_dwordx4 v94, s[36:39], s84 offen lds
  s_add_u32 m0, s11, 21504
  s_add_u32 s84, s84, 8192
  buffer_load_dwordx4 v95, s[36:39], s84 offen lds
  s_add_u32 m0, s11, 22528
  s_add_u32 s84, s84, 8192
  buffer_load_dwordx4 v94, s[36:39], s84 offen lds
  s_add_u32 m0, s11, 23552
  s_add_u32 s84, s84, 8192
  buffer_load_dwordx4 v95, s[36:39], s84 offen lds
  s_branch Lx_17
Lx_16:
  s_add_u32 s84, s6, 0
  s_and_b32 s84, s84, 7
  s_lshl_b32 s84, s84, 7
  s_add_u32 s84, s84, s10
  s_add_u32 m0, s11, 0
  s_nop 0
  buffer_load_dwordx4 v94, s[36:39], s84 offen lds
  s_add_u32 m0, s11, 1024
  s_add_u32 s84, s84, 8192
  buffer_load_dwordx4 v95, s[36:39], s84 offen lds
  s_add_u32 m0, s11, 2048
  s_add_u32 s84, s84, 8192
  buffer_load_dwordx4 v94, s[36:39], s84 offen lds
  s_add_u32 m0, s11, 3072
  s_add_u32 s84, s84, 8192
  buffer_load_dwordx4 v95, s[36:39], s84 offen lds
  s_add_u32 m0, s11, 4096
  s_add_u32 s84, s84, 8192
  buffer_load_dwordx4 v94, s[36:39], s84 offen lds
  s_add_u32 m0, s11, 5120
  s_add_u32 s84, s84, 8192
  buffer_load_dwordx4 v95, s[36:39], s84 offen lds
  s_add_u32 m0, s11, 6144
  s_add_u32 s84, s84, 8192
  buffer_load_dwordx4 v94, s[36:39], s84 offen lds
  s_add_u32 m0, s11, 7168
  s_add_u32 s84, s84, 8192
  buffer_load_dwordx4 v95, s[36:39], s84 offen lds
Lx_17:
  v_lshlrev_b32 v109, 4, v1
  s_lshl_b32 s88, s80, 2
  s_add_u32 s88, s88, s3
  s_lshl_b32 s88, s88, 10
  s_add_u32 s88, s88, 32768
  buffer_load_dwordx4 v[8:11], v109, s[76:79], s88 offen sc1
  v_lshrrev_b32 v103, 4, v1
  v_lshlrev_b32 v88, 8, v103
  v_bfe_u32 v111, v1, 2, 2
  v_lshl_add_u32 v88, v111, 5, v88
  v_and_b32 v111, 3, v1
  v_lshl_add_u32 v88, v111, 3, v88
  v_and_b32 v111, 1, v103
  v_lshlrev_b32 v111, 7, v111
  v_xor_b32 v88, v88, v111
  v_xor_b32 v89, 128, v88
  v_add_u32 v88, 98304, v88
  v_add_u32 v89, 98304, v89
  v_and_b32 v96, 15, v1
  v_cmp_eq_u32 vcc, 1, v96
  v_mov_b32 v102, 0
  v_mov_b32 v99, 1024
  v_cndmask_b32 v102, v102, v99, vcc
  v_lshl_add_u32 v102, v103, 4, v102
  s_lshl_b32 s86, s3, 8
  s_add_u32 s86, s86, 155648
  v_add_u32 v102, s86, v102
  s_lshl_b32 s86, s3, 12
  v_add_u32 v100, s86, v88
  v_add_u32 v101, s86, v89
  s_mul_i32 s86, s3, 384
  s_add_u32 s86, s86, 147456
  v_lshl_add_u32 v99, v96, 3, s86
  s_cmp_lt_u32 s98, 2
  s_cbranch_scc1 Lb4_19
  s_waitcnt vmcnt(17)
  s_barrier
  s_branch Lb4_20
Lb4_19:
  s_waitcnt vmcnt(1)
  s_barrier
  s_add_u32 s84, s6, 1
  s_and_b32 s84, s84, 7
  s_lshl_b32 s84, s84, 7
  s_add_u32 s84, s84, s10
  s_add_u32 m0, s11, 8192
  s_nop 0
  buffer_load_dwordx4 v94, s[36:39], s84 offen lds
  s_add_u32 m0, s11, 9216
  s_add_u32 s84, s84, 8192
  buffer_load_dwordx4 v95, s[36:39], s84 offen lds
  s_add_u32 m0, s11, 10240
  s_add_u32 s84, s84, 8192
  buffer_load_dwordx4 v94, s[36:39], s84 offen lds
  s_add_u32 m0, s11, 11264
  s_add_u32 s84, s84, 8192
  buffer_load_dwordx4 v95, s[36:39], s84 offen lds
  s_add_u32 m0, s11, 12288
  s_add_u32 s84, s84, 8192
  buffer_load_dwordx4 v94, s[36:39], s84 offen lds
  s_add_u32 m0, s11, 13312
  s_add_u32 s84, s84, 8192
  buffer_load_dwordx4 v95, s[36:39], s84 offen lds
  s_add_u32 m0, s11, 14336
  s_add_u32 s84, s84, 8192
  buffer_load_dwordx4 v94, s[36:39], s84 offen lds
  s_add_u32 m0, s11, 15360
  s_add_u32 s84, s84, 8192
  buffer_load_dwordx4 v95, s[36:39], s84 offen lds
  s_add_u32 s84, s6, 2
  s_and_b32 s84, s84, 7
  s_lshl_b32 s84, s84, 7
  s_add_u32 s84, s84, s10
  s_add_u32 m0, s11, 16384
  s_nop 0
  buffer_load_dwordx4 v94, s[36:39], s84 offen lds
  s_add_u32 m0, s11, 17408
  s_add_u32 s84, s84, 8192
  buffer_load_dwordx4 v95, s[36:39], s84 offen lds
  s_add_u32 m0, s11, 18432
  s_add_u32 s84, s84, 8192
  buffer_load_dwordx4 v94, s[36:39], s84 offen lds
  s_add_u32 m0, s11, 19456
  s_add_u32 s84, s84, 8192
  buffer_load_dwordx4 v95, s[36:39], s84 offen lds
  s_add_u32 m0, s11, 20480
  s_add_u32 s84, s84, 8192
  buffer_load_dwordx4 v94, s[36:39], s84 offen lds
  s_add_u32 m0, s11, 21504
  s_add_u32 s84, s84, 8192
  buffer_load_dwordx4 v95, s[36:39], s84 offen lds
  s_add_u32 m0, s11, 22528
  s_add_u32 s84, s84, 8192
  buffer_load_dwordx4 v94, s[36:39], s84 offen lds
  s_add_u32 m0, s11, 23552
  s_add_u32 s84, s84, 8192
  buffer_load_dwordx4 v95, s[36:39], s84 offen lds
  buffer_load_dwordx4 v[8:11], v109, s[76:79], s88 offen sc1
Lb4_20:
  s_setprio 1
  ds_read_b128 v[176:179], v102 offset:0
  ds_read_b128 v[180:183], v102 offset:64
  ds_read_b128 v[184:187], v102 offset:128
  ds_read_b128 v[188:191], v102 offset:192
  ds_read_b64_tr_b16 v[128:129], v100 offset:0
  ds_read_b64_tr_b16 v[130:131], v101 offset:0
  ds_read_b64_tr_b16 v[132:133], v100 offset:16384
  ds_read_b64_tr_b16 v[134:135], v101 offset:16384
  ds_read_b64_tr_b16 v[136:137], v100 offset:32768
  ds_read_b64_tr_b16 v[138:139], v101 offset:32768
  ds_read_b64_tr_b16 v[140:141], v100 offset:1024
  ds_read_b64_tr_b16 v[142:143], v101 offset:1024
  ds_read_b64_tr_b16 v[144:145], v100 offset:17408
  ds_read_b64_tr_b16 v[146:147], v101 offset:17408
  ds_read_b64_tr_b16 v[148:149], v100 offset:33792
  ds_read_b64_tr_b16 v[150:151], v101 offset:33792
  s_waitcnt vmcnt(9)
  s_barrier
  s_add_u32 s84, s6, 3
  s_and_b32 s84, s84, 7
  s_lshl_b32 s84, s84, 7
  s_add_u32 s84, s84, s10
  s_add_u32 m0, s11, 0
  s_nop 0
  buffer_load_dwordx4 v94, s[36:39], s84 offen lds
  s_add_u32 m0, s11, 1024
  s_add_u32 s84, s84, 8192
  buffer_load_dwordx4 v95, s[36:39], s84 offen lds
  s_add_u32 m0, s11, 2048
  s_add_u32 s84, s84, 8192
  buffer_load_dwordx4 v94, s[36:39], s84 offen lds
  s_add_u32 m0, s11, 3072
  s_add_u32 s84, s84, 8192
  buffer_load_dwordx4 v95, s[36:39], s84 offen lds
  s_add_u32 m0, s11, 4096
  s_add_u32 s84, s84, 8192
  buffer_load_dwordx4 v94, s[36:39], s84 offen lds
  s_add_u32 m0, s11, 5120
  s_add_u32 s84, s84, 8192
  buffer_load_dwordx4 v95, s[36:39], s84 offen lds
  s_add_u32 m0, s11, 6144
  s_add_u32 s84, s84, 8192
  buffer_load_dwordx4 v94, s[36:39], s84 offen lds
  s_add_u32 m0, s11, 7168
  s_add_u32 s84, s84, 8192
  buffer_load_dwordx4 v95, s[36:39], s84 offen lds
  s_waitcnt lgkmcnt(0)
  ds_read_b64_tr_b16 v[152:153], v100 offset:2048
  ds_read_b64_tr_b16 v[154:155], v101 offset:2048
  ds_read_b64_tr_b16 v[156:157], v100 offset:18432
  ds_read_b64_tr_b16 v[158:159], v101 offset:18432
  ds_read_b64_tr_b16 v[160:161], v100 offset:34816
  ds_read_b64_tr_b16 v[162:163], v101 offset:34816
  ds_read_b64_tr_b16 v[164:165], v100 offset:3072
  ds_read_b64_tr_b16 v[166:167], v101 offset:3072
  ds_read_b64_tr_b16 v[168:169], v100 offset:19456
  ds_read_b64_tr_b16 v[170:171], v101 offset:19456
  ds_read_b64_tr_b16 v[172:173], v100 offset:35840
  ds_read_b64_tr_b16 v[174:175], v101 offset:35840
  v_mfma_f32_16x16x32_bf16 v[40:43], v[176:179], v[128:131], 0
  v_mfma_f32_16x16x32_bf16 v[44:47], v[176:179], v[132:135], 0
  v_mfma_f32_16x16x32_bf16 v[48:51], v[176:179], v[136:139], 0
  v_mfma_f32_16x16x32_bf16 v[40:43], v[180:183], v[140:143], v[40:43]
  v_mfma_f32_16x16x32_bf16 v[44:47], v[180:183], v[144:147], v[44:47]
  v_mfma_f32_16x16x32_bf16 v[48:51], v[180:183], v[148:151], v[48:51]
  s_waitcnt lgkmcnt(0)
  v_mfma_f32_16x16x32_bf16 v[40:43], v[184:187], v[152:155], v[40:43]
  v_mfma_f32_16x16x32_bf16 v[44:47], v[184:187], v[156:159], v[44:47]
  v_mfma_f32_16x16x32_bf16 v[48:51], v[184:187], v[160:163], v[48:51]
  v_mfma_f32_16x16x32_bf16 v[40:43], v[188:191], v[164:167], v[40:43]
  v_mfma_f32_16x16x32_bf16 v[44:47], v[188:191], v[168:171], v[44:47]
  v_mfma_f32_16x16x32_bf16 v[48:51], v[188:191], v[172:175], v[48:51]
  s_waitcnt vmcnt(9)
  s_barrier
  s_add_u32 s84, s6, 4
  s_and_b32 s84, s84, 7
  s_lshl_b32 s84, s84, 7
  s_add_u32 s84, s84, s10
  s_add_u32 m0, s11, 8192
  s_nop 0
  buffer_load_dwordx4 v94, s[36:39], s84 offen lds
  s_add_u32 m0, s11, 9216
  s_add_u32 s84, s84, 8192
  buffer_load_dwordx4 v95, s[36:39], s84 offen lds
  s_add_u32 m0, s11, 10240
  s_add_u32 s84, s84, 8192
  buffer_load_dwordx4 v94, s[36:39], s84 offen lds
  s_add_u32 m0, s11, 11264
  s_add_u32 s84, s84, 8192
  buffer_load_dwordx4 v95, s[36:39], s84 offen lds
  s_add_u32 m0, s11, 12288
  s_add_u32 s84, s84, 8192
  buffer_load_dwordx4 v94, s[36:39], s84 offen lds
  s_add_u32 m0, s11, 13312
  s_add_u32 s84, s84, 8192
  buffer_load_dwordx4 v95, s[36:39], s84 offen lds
  s_add_u32 m0, s11, 14336
  s_add_u32 s84, s84, 8192
  buffer_load_dwordx4 v94, s[36:39], s84 offen lds
  s_add_u32 m0, s11, 15360
  s_add_u32 s84, s84, 8192
  buffer_load_dwordx4 v95, s[36:39], s84 offen lds
  s_mov_b32 exec_lo, 0x0000ffff
  s_mov_b32 exec_hi, 0x00000000
  ds_write_b64 v99, v[40:41] offset:0
  ds_write_b64 v99, v[44:45] offset:128
  ds_write_b64 v99, v[48:49] offset:256
  s_mov_b64 exec, -1
  v_mov_b32 v42, 160860
  v_mov_b32 v43, 1
  s_mov_b32 exec_lo, 0x00000001
  s_mov_b32 exec_hi, 0x00000000
  ds_add_rtn_u32 v43, v42, v43
  s_waitcnt lgkmcnt(0)
  s_mov_b64 exec, -1
  v_readfirstlane_b32 s84, v43
  s_nop 0
  s_cmp_lg_u32 s84, 3
  s_cbranch_scc1 Lub_21
  v_lshrrev_b32 v40, 4, v1
  v_lshlrev_b32 v40, 7, v40
  v_and_b32 v41, 15, v1
  v_lshl_add_u32 v40, v41, 3, v40
  v_add_u32 v40, 147456, v40
  v_lshlrev_b32 v41, 2, v1
  v_add_u32 v41, 157696, v41
  s_mov_b32 exec_lo, 0xffffffff
  s_mov_b32 exec_hi, 0x0000ffff
  ds_read_b64 v[52:53], v40 offset:0
  ds_read_b64 v[54:55], v40 offset:384
  ds_read_b64 v[56:57], v40 offset:768
  ds_read_b64 v[58:59], v40 offset:1152
  s_waitcnt lgkmcnt(0)
  v_add_f32 v52, v52, v54
  v_add_f32 v53, v53, v55
  v_add_f32 v56, v56, v58
  v_add_f32 v57, v57, v59
  v_add_f32 v52, v52, v56
  v_add_f32 v53, v53, v57
  ds_write_b32 v41, v52
  ds_write_b32 v41, v53 offset:192
  s_mov_b64 exec, -1
Lub_21:
  s_waitcnt vmcnt(8)
  s_barrier
  s_add_u32 s84, s6, 5
  s_and_b32 s84, s84, 7
  s_lshl_b32 s84, s84, 7
  s_add_u32 s84, s84, s10
  s_add_u32 m0, s11, 16384
  s_nop 0
  buffer_load_dwordx4 v94, s[36:39], s84 offen lds
  s_add_u32 m0, s11, 17408
  s_add_u32 s84, s84, 8192
  buffer_load_dwordx4 v95, s[36:39], s84 offen lds
  s_add_u32 m0, s11, 18432
  s_add_u32 s84, s84, 8192
  buffer_load_dwordx4 v94, s[36:39], s84 offen lds
  s_add_u32 m0, s11, 19456
  s_add_u32 s84, s84, 8192
  buffer_load_dwordx4 v95, s[36:39], s84 offen lds
  s_add_u32 m0, s11, 20480
  s_add_u32 s84, s84, 8192
  buffer_load_dwordx4 v94, s[36:39], s84 offen lds
  s_add_u32 m0, s11, 21504
  s_add_u32 s84, s84, 8192
  buffer_load_dwordx4 v95, s[36:39], s84 offen lds
  s_add_u32 m0, s11, 22528
  s_add_u32 s84, s84, 8192
  buffer_load_dwordx4 v94, s[36:39], s84 offen lds
  s_add_u32 m0, s11, 23552
  s_add_u32 s84, s84, 8192
  buffer_load_dwordx4 v95, s[36:39], s84 offen lds
  s_mov_b32 s92, 0
  v_cmp_ne_u32 s[8:9], s83, v10
Lmp_22:
  s_nop 0
  s_cmp_eq_u64 s[8:9], 0
  s_cbranch_scc1 Lmpd_23
  s_add_u32 s92, s92, 1
  s_cmp_ge_u32 s92, 40000
  s_cbranch_scc1 Lmpd_23
  s_sleep 1
  s_mov_b64 exec, s[8:9]
  s_cbranch_execz Lmps_24
  buffer_load_dwordx4 v[8:11], v109, s[76:79], s88 offen sc1
Lmps_24:
  s_waitcnt vmcnt(0)
  s_mov_b64 exec, s[8:9]
  v_cmp_ne_u32 s[8:9], s83, v10
  s_mov_b64 exec, -1
  s_branch Lmp_22
Lmpd_23:
  v_mul_f32 v8, v8, v9
  v_sub_f32 v8, 0, v8
  s_lshl_b32 s85, s3, 8
  s_add_u32 s85, s85, 158208
  v_lshl_add_u32 v104, v1, 2, s85
  ds_write_b32 v104, v9
  ds_write_b32 v104, v8 offset:1024
  s_waitcnt vmcnt(8)
  s_barrier
  s_add_u32 s84, s6, 6
  s_and_b32 s84, s84, 7
  s_lshl_b32 s84, s84, 7
  s_add_u32 s84, s84, s10
  s_add_u32 m0, s11, 0
  s_nop 0
  buffer_load_dwordx4 v94, s[36:39], s84 offen lds
  s_add_u32 m0, s11, 1024
  s_add_u32 s84, s84, 8192
  buffer_load_dwordx4 v95, s[36:39], s84 offen lds
  s_add_u32 m0, s11, 2048
  s_add_u32 s84, s84, 8192
  buffer_load_dwordx4 v94, s[36:39], s84 offen lds
  s_add_u32 m0, s11, 3072
  s_add_u32 s84, s84, 8192
  buffer_load_dwordx4 v95, s[36:39], s84 offen lds
  s_add_u32 m0, s11, 4096
  s_add_u32 s84, s84, 8192
  buffer_load_dwordx4 v94, s[36:39], s84 offen lds
  s_add_u32 m0, s11, 5120
  s_add_u32 s84, s84, 8192
  buffer_load_dwordx4 v95, s[36:39], s84 offen lds
  s_add_u32 m0, s11, 6144
  s_add_u32 s84, s84, 8192
  buffer_load_dwordx4 v94, s[36:39], s84 offen lds
  s_add_u32 m0, s11, 7168
  s_add_u32 s84, s84, 8192
  buffer_load_dwordx4 v95, s[36:39], s84 offen lds
  s_waitcnt vmcnt(8)
  s_barrier
  s_add_u32 s84, s6, 7
  s_and_b32 s84, s84, 7
  s_lshl_b32 s84, s84, 7
  s_add_u32 s84, s84, s10
  s_add_u32 m0, s11, 8192
  s_nop 0
  buffer_load_dwordx4 v94, s[36:39], s84 offen lds
  s_add_u32 m0, s11, 9216
  s_add_u32 s84, s84, 8192
  buffer_load_dwordx4 v95, s[36:39], s84 offen lds
  s_add_u32 m0, s11, 10240
  s_add_u32 s84, s84, 8192
  buffer_load_dwordx4 v94, s[36:39], s84 offen lds
  s_add_u32 m0, s11, 11264
  s_add_u32 s84, s84, 8192
  buffer_load_dwordx4 v95, s[36:39], s84 offen lds
  s_add_u32 m0, s11, 12288
  s_add_u32 s84, s84, 8192
  buffer_load_dwordx4 v94, s[36:39], s84 offen lds
  s_add_u32 m0, s11, 13312
  s_add_u32 s84, s84, 8192
  buffer_load_dwordx4 v95, s[36:39], s84 offen lds
  s_add_u32 m0, s11, 14336
  s_add_u32 s84, s84, 8192
  buffer_load_dwordx4 v94, s[36:39], s84 offen lds
  s_add_u32 m0, s11, 15360
  s_add_u32 s84, s84, 8192
  buffer_load_dwordx4 v95, s[36:39], s84 offen lds
  s_sub_u32 s85, s98, 2
  s_cmp_lt_u32 s85, 4
  s_cbranch_scc0 Llate_25
  s_mul_i32 s84, s3, 256
  buffer_load_ushort v176, v92, s[64:67], s84 offen offset:0
  buffer_load_ushort v177, v92, s[64:67], s84 offen offset:64
  buffer_load_ushort v178, v92, s[64:67], s84 offen offset:128
  buffer_load_ushort v179, v92, s[64:67], s84 offen offset:192
  s_lshl_b32 s85, s98, 5
  s_add_u32 s85, s85, s99
  s_lshl_b32 s85, s85, 5
  s_mul_i32 s84, s3, 786432
  s_add_u32 s84, s84, s85
  buffer_load_dwordx4 v[128:131], v91, s[68:71], s84 offen
  s_add_u32 s84, s84, 196608
  buffer_load_dwordx4 v[132:135], v91, s[68:71], s84 offen
  s_add_u32 s84, s84, 196608
  buffer_load_dwordx4 v[136:139], v91, s[68:71], s84 offen
  s_waitcnt vmcnt(15)
  s_barrier
  s_lshl_b32 s85, s98, 5
  s_add_u32 s85, s85, s99
  s_lshl_b32 s85, s85, 5
  s_mul_i32 s84, s3, 786432
  s_add_u32 s84, s84, s85
  s_add_u32 s84, s84, 589824
  buffer_load_dwordx4 v[140:143], v91, s[68:71], s84 offen
  s_waitcnt vmcnt(8)
  s_barrier
  s_setprio 0
  s_waitcnt lgkmcnt(0)
  s_barrier
  s_waitcnt vmcnt(4)
  v_lshlrev_b32 v176, 16, v176
  v_lshlrev_b32 v177, 16, v177
  v_lshlrev_b32 v178, 16, v178
  v_lshlrev_b32 v179, 16, v179
  v_mul_f32 v48, 0xbfb8aa3b, v176
  v_mul_f32 v49, 0xbfb8aa3b, v177
  v_mul_f32 v50, 0xbfb8aa3b, v178
  v_mul_f32 v51, 0xbfb8aa3b, v179
  v_exp_f32 v48, v48
  v_exp_f32 v49, v49
  v_exp_f32 v50, v50
  v_exp_f32 v51, v51
  v_add_f32 v48, 1.0, v48
  v_add_f32 v49, 1.0, v49
  v_add_f32 v50, 1.0, v50
  v_add_f32 v51, 1.0, v51
  v_rcp_f32 v48, v48
  v_rcp_f32 v49, v49
  v_rcp_f32 v50, v50
  v_rcp_f32 v51, v51
  v_mul_f32 v176, v176, v48
  v_mul_f32 v177, v177, v49
  v_mul_f32 v178, v178, v50
  v_mul_f32 v179, v179, v51
  s_waitcnt vmcnt(3)
  v_lshlrev_b32 v40, 16, v128
  v_and_b32 v41, 0xffff0000, v128
  v_lshlrev_b32 v42, 16, v129
  v_and_b32 v43, 0xffff0000, v129
  v_lshlrev_b32 v44, 16, v130
  v_and_b32 v45, 0xffff0000, v130
  v_lshlrev_b32 v46, 16, v131
  v_and_b32 v47, 0xffff0000, v131
  v_mul_f32 v40, v176, v40
  v_mul_f32 v41, v176, v41
  v_mul_f32 v42, v176, v42
  v_mul_f32 v43, v176, v43
  v_mul_f32 v44, v176, v44
  v_mul_f32 v45, v176, v45
  v_mul_f32 v46, v176, v46
  v_mul_f32 v47, v176, v47
  s_waitcnt vmcnt(2)
  v_lshlrev_b32 v48, 16, v132
  v_and_b32 v49, 0xffff0000, v132
  v_lshlrev_b32 v50, 16, v133
  v_and_b32 v51, 0xffff0000, v133
  v_lshlrev_b32 v52, 16, v134
  v_and_b32 v53, 0xffff0000, v134
  v_lshlrev_b32 v54, 16, v135
  v_and_b32 v55, 0xffff0000, v135
  v_fmac_f32 v40, v177, v48
  v_fmac_f32 v41, v177, v49
  v_fmac_f32 v42, v177, v50
  v_fmac_f32 v43, v177, v51
  v_fmac_f32 v44, v177, v52
  v_fmac_f32 v45, v177, v53
  v_fmac_f32 v46, v177, v54
  v_fmac_f32 v47, v177, v55
  s_waitcnt vmcnt(1)
  v_lshlrev_b32 v48, 16, v136
  v_and_b32 v49, 0xffff0000, v136
  v_lshlrev_b32 v50, 16, v137
  v_and_b32 v51, 0xffff0000, v137
  v_lshlrev_b32 v52, 16, v138
  v_and_b32 v53, 0xffff0000, v138
  v_lshlrev_b32 v54, 16, v139
  v_and_b32 v55, 0xffff0000, v139
  v_fmac_f32 v40, v178, v48
  v_fmac_f32 v41, v178, v49
  v_fmac_f32 v42, v178, v50
  v_fmac_f32 v43, v178, v51
  v_fmac_f32 v44, v178, v52
  v_fmac_f32 v45, v178, v53
  v_fmac_f32 v46, v178, v54
  v_fmac_f32 v47, v178, v55
  s_waitcnt vmcnt(0)
  v_lshlrev_b32 v48, 16, v140
  v_and_b32 v49, 0xffff0000, v140
  v_lshlrev_b32 v50, 16, v141
  v_and_b32 v51, 0xffff0000, v141
  v_lshlrev_b32 v52, 16, v142
  v_and_b32 v53, 0xffff0000, v142
  v_lshlrev_b32 v54, 16, v143
  v_and_b32 v55, 0xffff0000, v143
  v_fmac_f32 v40, v179, v48
  v_fmac_f32 v41, v179, v49
  v_fmac_f32 v42, v179, v50
  v_fmac_f32 v43, v179, v51
  v_fmac_f32 v44, v179, v52
  v_fmac_f32 v45, v179, v53
  v_fmac_f32 v46, v179, v54
  v_fmac_f32 v47, v179, v55
  v_permlane32_swap_b32 v40, v41
  v_add_f32 v40, v40, v41
  v_permlane32_swap_b32 v42, v43
  v_add_f32 v42, v42, v43
  v_permlane32_swap_b32 v44, v45
  v_add_f32 v44, v44, v45
  v_permlane32_swap_b32 v46, v47
  v_add_f32 v46, v46, v47
  v_permlane16_swap_b32 v40, v42
  v_add_f32 v40, v40, v42
  v_permlane16_swap_b32 v44, v46
  v_add_f32 v44, v44, v46
  v_add_f32_dpp v40, v40, v40 row_shr:2 row_mask:0xf bank_mask:0xf
  s_nop 0
  v_add_f32_dpp v44, v44, v44 row_shr:2 row_mask:0xf bank_mask:0xf
  v_add_f32_dpp v40, v40, v40 row_shr:4 row_mask:0xf bank_mask:0xf
  s_nop 0
  v_add_f32_dpp v44, v44, v44 row_shr:4 row_mask:0xf bank_mask:0xf
  v_add_f32_dpp v40, v40, v40 row_shr:8 row_mask:0xf bank_mask:0xf
  s_nop 0
  v_add_f32_dpp v44, v44, v44 row_shr:8 row_mask:0xf bank_mask:0xf
  v_lshrrev_b32 v48, 4, v1
  v_and_b32 v49, 1, v48
  v_lshlrev_b32 v49, 1, v49
  v_lshrrev_b32 v48, 1, v48
  v_or_b32 v48, v48, v49
  v_and_b32 v49, 1, v1
  v_lshl_add_u32 v48, v49, 3, v48
  s_lshl_b32 s85, s3, 6
  s_add_u32 s85, s85, 160256
  v_lshl_add_u32 v48, v48, 2, s85
  s_mov_b32 exec_lo, 0xc000c000
  s_mov_b32 exec_hi, 0xc000c000
  ds_write_b32 v48, v40
  ds_write_b32 v48, v44 offset:16
  s_mov_b64 exec, -1
  v_mov_b32 v48, 160832
  v_mov_b32 v49, 1
  s_mov_b32 exec_lo, 0x00000001
  s_mov_b32 exec_hi, 0x00000000
  ds_add_rtn_u32 v49, v48, v49
  s_waitcnt lgkmcnt(0)
  s_mov_b64 exec, -1
  v_readfirstlane_b32 s84, v49
  s_nop 0
  s_cmp_lg_u32 s84, 3
  s_cbranch_scc1 Lnl_27
  v_and_b32 v48, 15, v1
  v_lshlrev_b32 v49, 2, v48
  v_add_u32 v49, 160256, v49
  ds_read_b32 v40, v49 offset:0
  ds_read_b32 v41, v49 offset:64
  ds_read_b32 v42, v49 offset:128
  ds_read_b32 v43, v49 offset:192
  v_lshlrev_b32 v48, 3, v48
  s_lshl_b32 s84, s98, 5
  s_add_u32 s84, s84, s99
  s_lshl_b32 s84, s84, 7
  s_add_u32 s84, s84, 4096
  v_mov_b32 v49, s83
  s_waitcnt lgkmcnt(0)
  v_add_f32 v40, v40, v41
  v_add_f32 v42, v42, v43
  v_add_f32 v40, v40, v42
  v_mov_b32 v41, v49
  s_mov_b32 exec_lo, 0x0000ffff
  s_mov_b32 exec_hi, 0x00000000
  buffer_store_dwordx2 v[40:41], v48, s[76:79], s84 offen sc1
  s_mov_b64 exec, -1
Lnl_27:
  s_branch Llate_26
Llate_25:
  s_waitcnt vmcnt(8)
  s_barrier
  s_waitcnt vmcnt(0)
  s_barrier
  s_setprio 0
  s_waitcnt lgkmcnt(0)
  s_barrier
Llate_26:
  v_and_b32 v9, 31, v1
  v_cmp_eq_u32 vcc, 16, v9
  v_mov_b32 v9, 0
  v_mov_b32 v10, 0x3f803f80
  v_cndmask_b32 v9, v9, v10, vcc
  v_mov_b32 v72, v9
  v_mov_b32 v73, v9
  v_mov_b32 v74, v9
  v_mov_b32 v75, v9
  v_mov_b32 v76, v9
  v_mov_b32 v77, v9
  v_mov_b32 v78, v9
  v_mov_b32 v79, v9
  v_mov_b32 v80, v9
  v_mov_b32 v81, v9
  v_mov_b32 v82, v9
  v_mov_b32 v83, v9
  v_mov_b32 v84, v9
  v_mov_b32 v85, v9
  v_mov_b32 v86, v9
  v_mov_b32 v87, v9
  v_mov_b32 v88, v9
  v_mov_b32 v89, v9
  v_mov_b32 v90, v9
  v_mov_b32 v91, v9
  v_mov_b32 v92, v9
  v_mov_b32 v93, v9
  v_mov_b32 v94, v9
  v_mov_b32 v95, v9
  v_mov_b32 v96, v9
  v_mov_b32 v97, v9
  v_mov_b32 v98, v9
  v_mov_b32 v99, v9
  v_mov_b32 v100, v9
  v_mov_b32 v101, v9
  v_mov_b32 v102, v9
  v_mov_b32 v103, v9
  v_mov_b32 v48, 0
  v_mov_b32 v49, 0
  v_mov_b32 v50, 0
  v_mov_b32 v51, 0
  v_mov_b32 v52, 0
  v_mov_b32 v53, 0
  v_mov_b32 v54, 0
  v_mov_b32 v55, 0
  v_mov_b32 v56, 0
  v_mov_b32 v57, 0
  v_mov_b32 v58, 0
  v_mov_b32 v59, 0
  v_mov_b32 v60, 0
  v_mov_b32 v61, 0
  v_mov_b32 v62, 0
  v_mov_b32 v63, 0
  s_barrier
  s_lshl_b32 s85, s3, 10
  s_add_u32 s85, s85, 149504
  v_lshl_add_u32 v15, v1, 4, s85
  ds_read_b128 v[112:115], v15
Lp2e_2:
  s_and_b32 s85, s82, 3
  s_lshl_b32 s85, s85, 1
  s_bitcmp1_b32 s82, 2
  s_addc_u32 s85, s85, 0
  s_lshl_b32 s85, s85, 2
  s_add_u32 s85, s85, 160800
  v_mov_b32 v14, s85
  ds_read_b32 v14, v14
  v_mov_b32 v2, 0xdddd
  v_lshlrev_b32 v4, 4, v1
  v_lshrrev_b32 v6, 5, v1
  v_and_b32 v7, 15, v1
  v_lshlrev_b32 v7, 4, v7
  v_lshl_add_u32 v5, v6, 9, v7
  v_add_u32 v5, 8192, v5
  s_mov_b32 s96, 0x0000ffff
  s_mov_b32 s97, 0x0000ffff
  v_and_b32 v6, 7, v1
  v_lshlrev_b32 v6, 2, v6
  v_add_u32 v6, 160768, v6
  ds_read_b32 v8, v6
  v_bfe_u32 v12, v1, 2, 3
  v_lshlrev_b32 v12, 7, v12
  v_and_b32 v9, 3, v1
  v_lshl_add_u32 v12, v9, 3, v12
  s_cmp_ge_u32 s82, 4
  s_cbranch_scc1 Lini_28
  s_setprio 2
  v_and_b32 v9, 31, v1
  v_cmp_eq_u32 vcc, 16, v9
  v_mov_b32 v9, 0
  v_mov_b32 v10, 0x3f803f80
  v_cndmask_b32 v9, v9, v10, vcc
  v_mov_b32 v72, v9
  v_mov_b32 v73, v9
  v_mov_b32 v74, v9
  v_mov_b32 v75, v9
  v_mov_b32 v76, v9
  v_mov_b32 v77, v9
  v_mov_b32 v78, v9
  v_mov_b32 v79, v9
  v_mov_b32 v80, v9
  v_mov_b32 v81, v9
  v_mov_b32 v82, v9
  v_mov_b32 v83, v9
  v_mov_b32 v84, v9
  v_mov_b32 v85, v9
  v_mov_b32 v86, v9
  v_mov_b32 v87, v9
  v_mov_b32 v88, v9
  v_mov_b32 v89, v9
  v_mov_b32 v90, v9
  v_mov_b32 v91, v9
  v_mov_b32 v92, v9
  v_mov_b32 v93, v9
  v_mov_b32 v94, v9
  v_mov_b32 v95, v9
  v_mov_b32 v96, v9
  v_mov_b32 v97, v9
  v_mov_b32 v98, v9
  v_mov_b32 v99, v9
  v_mov_b32 v100, v9
  v_mov_b32 v101, v9
  v_mov_b32 v102, v9
  v_mov_b32 v103, v9
  v_mov_b32 v48, 0
  v_mov_b32 v49, 0
  v_mov_b32 v50, 0
  v_mov_b32 v51, 0
  v_mov_b32 v52, 0
  v_mov_b32 v53, 0
  v_mov_b32 v54, 0
  v_mov_b32 v55, 0
  v_mov_b32 v56, 0
  v_mov_b32 v57, 0
  v_mov_b32 v58, 0
  v_mov_b32 v59, 0
  v_mov_b32 v60, 0
  v_mov_b32 v61, 0
  v_mov_b32 v62, 0
  v_mov_b32 v63, 0
Lini_28:
  s_cmp_lt_u32 s82, 4
  s_cbranch_scc1 Lprio_29
  s_setprio 1
Lprio_29:
  s_waitcnt lgkmcnt(0)
  v_readfirstlane_b32 s93, v14
  v_max_f32_dpp v8, v8, v8 row_shr:1 row_mask:0xf bank_mask:0xf
  s_nop 1
  v_max_f32_dpp v8, v8, v8 row_shr:2 row_mask:0xf bank_mask:0xf
  s_nop 1
  v_max_f32_dpp v8, v8, v8 row_shr:4 row_mask:0xf bank_mask:0xf
  s_nop 1
  v_max_f32_dpp v8, v8, v8 row_shr:8 row_mask:0xf bank_mask:0xf
  s_nop 0
  v_readlane_b32 s95, v8, 15
  s_cmp_ge_u32 s82, 4
  s_cbranch_scc1 Lkvf_34
  s_lshl_b32 s84, s81, 3
  s_add_u32 s84, s84, s80
  s_lshl_b32 s84, s84, 4
  s_add_u32 s84, s84, s82
  s_lshl_b32 s84, s84, 3
  s_add_u32 s84, s84, 65536
  v_mov_b32 v6, s91
  v_mov_b32 v7, s83
  v_mov_b32 v11, 0
  s_waitcnt vmcnt(0)
  s_mov_b32 exec_lo, 0x00000001
  s_mov_b32 exec_hi, 0x00000000
  buffer_store_dwordx2 v[6:7], v11, s[76:79], s84 offen sc1
  s_mov_b64 exec, -1
  s_setprio 0
Lkvf_34:
  s_mov_b32 s94, 0
  v_mov_b32 v8, s93
  v_mul_f32 v8, s95, v8
  v_mov_b32 v9, 0x45800000
  v_cmp_le_f32 vcc, v8, v9
  s_cbranch_vccz Lslow0_30
  ds_read_b128 v[64:67], v4 offset:0
  ds_read_b128 v[68:71], v4 offset:1024
  s_mov_b64 exec, s[96:97]
  ds_read_b128 v[72:75], v5 offset:0
  ds_read_b128 v[76:79], v5 offset:256
  ds_read_b128 v[80:83], v5 offset:1024
  ds_read_b128 v[84:87], v5 offset:1280
  s_mov_b64 exec, -1
  s_waitcnt lgkmcnt(5)
  v_mfma_f32_32x32x16_bf16 v[16:31], v[64:67], v[112:115], 0
  s_nop 11
  v_exp_f32 v16, v16
  v_exp_f32 v17, v17
  v_exp_f32 v18, v18
  v_exp_f32 v19, v19
  v_exp_f32 v20, v20
  s_waitcnt lgkmcnt(0)
  v_mfma_f32_32x32x16_bf16 v[32:47], v[68:71], v[112:115], 0
  ds_read_b128 v[64:67], v4 offset:2048
  v_exp_f32 v21, v21
  v_exp_f32 v22, v22
  v_exp_f32 v23, v23
  v_exp_f32 v24, v24
  v_exp_f32 v25, v25
  v_exp_f32 v26, v26
  v_exp_f32 v27, v27
  v_smfmac_f32_32x32x32_bf16 v[48:63], v[72:75], v[16:23], v2
  s_mov_b64 exec, s[96:97]
  ds_read_b128 v[88:91], v5 offset:2048
  ds_read_b128 v[92:95], v5 offset:2304
  ds_read_b128 v[96:99], v5 offset:3072
  ds_read_b128 v[100:103], v5 offset:3328
  s_mov_b64 exec, -1
  v_exp_f32 v28, v28
  v_exp_f32 v29, v29
  v_exp_f32 v30, v30
  v_exp_f32 v31, v31
  v_exp_f32 v32, v32
  v_exp_f32 v33, v33
  v_smfmac_f32_32x32x32_bf16 v[48:63], v[76:79], v[24:31], v2
  v_exp_f32 v34, v34
  v_exp_f32 v35, v35
  v_exp_f32 v36, v36
  s_waitcnt lgkmcnt(4)
  v_mfma_f32_32x32x16_bf16 v[16:31], v[64:67], v[112:115], 0
  ds_read_b128 v[68:71], v4 offset:3072
  v_exp_f32 v37, v37
  v_exp_f32 v38, v38
  v_exp_f32 v39, v39
  v_exp_f32 v40, v40
  v_exp_f32 v41, v41
  v_exp_f32 v42, v42
  v_exp_f32 v43, v43
  v_smfmac_f32_32x32x32_bf16 v[48:63], v[80:83], v[32:39], v2
  v_exp_f32 v44, v44
  v_exp_f32 v45, v45
  v_exp_f32 v46, v46
  v_exp_f32 v47, v47
  v_exp_f32 v16, v16
  v_exp_f32 v17, v17
  v_smfmac_f32_32x32x32_bf16 v[48:63], v[84:87], v[40:47], v2
  v_exp_f32 v18, v18
  v_exp_f32 v19, v19
  v_exp_f32 v20, v20
  s_waitcnt lgkmcnt(0)
  v_mfma_f32_32x32x16_bf16 v[32:47], v[68:71], v[112:115], 0
  ds_read_b128 v[64:67], v4 offset:4096
  v_exp_f32 v21, v21
  v_exp_f32 v22, v22
  v_exp_f32 v23, v23
  v_exp_f32 v24, v24
  v_exp_f32 v25, v25
  v_exp_f32 v26, v26
  v_exp_f32 v27, v27
  v_smfmac_f32_32x32x32_bf16 v[48:63], v[88:91], v[16:23], v2
  s_mov_b64 exec, s[96:97]
  ds_read_b128 v[72:75], v5 offset:4096
  ds_read_b128 v[76:79], v5 offset:4352
  ds_read_b128 v[80:83], v5 offset:5120
  ds_read_b128 v[84:87], v5 offset:5376
  s_mov_b64 exec, -1
  v_exp_f32 v28, v28
  v_exp_f32 v29, v29
  v_exp_f32 v30, v30
  v_exp_f32 v31, v31
  v_exp_f32 v32, v32
  v_exp_f32 v33, v33
  v_smfmac_f32_32x32x32_bf16 v[48:63], v[92:95], v[24:31], v2
  v_exp_f32 v34, v34
  v_exp_f32 v35, v35
  v_exp_f32 v36, v36
  s_waitcnt lgkmcnt(4)
  v_mfma_f32_32x32x16_bf16 v[16:31], v[64:67], v[112:115], 0
  ds_read_b128 v[68:71], v4 offset:5120
  v_exp_f32 v37, v37
  v_exp_f32 v38, v38
  v_exp_f32 v39, v39
  v_exp_f32 v40, v40
  v_exp_f32 v41, v41
  v_exp_f32 v42, v42
  v_exp_f32 v43, v43
  v_smfmac_f32_32x32x32_bf16 v[48:63], v[96:99], v[32:39], v2
  v_exp_f32 v44, v44
  v_exp_f32 v45, v45
  v_exp_f32 v46, v46
  v_exp_f32 v47, v47
  v_exp_f32 v16, v16
  v_exp_f32 v17, v17
  v_smfmac_f32_32x32x32_bf16 v[48:63], v[100:103], v[40:47], v2
  v_exp_f32 v18, v18
  v_exp_f32 v19, v19
  v_exp_f32 v20, v20
  s_waitcnt lgkmcnt(0)
  v_mfma_f32_32x32x16_bf16 v[32:47], v[68:71], v[112:115], 0
  ds_read_b128 v[64:67], v4 offset:6144
  v_exp_f32 v21, v21
  v_exp_f32 v22, v22
  v_exp_f32 v23, v23
  v_exp_f32 v24, v24
  v_exp_f32 v25, v25
  v_exp_f32 v26, v26
  v_exp_f32 v27, v27
  v_smfmac_f32_32x32x32_bf16 v[48:63], v[72:75], v[16:23], v2
  s_mov_b64 exec, s[96:97]
  ds_read_b128 v[88:91], v5 offset:6144
  ds_read_b128 v[92:95], v5 offset:6400
  ds_read_b128 v[96:99], v5 offset:7168
  ds_read_b128 v[100:103], v5 offset:7424
  s_mov_b64 exec, -1
  v_exp_f32 v28, v28
  v_exp_f32 v29, v29
  v_exp_f32 v30, v30
  v_exp_f32 v31, v31
  s_cmp_lt_u32 s82, 4
  s_cbranch_scc1 Lnopoll_35
  s_lshl_b32 s84, s81, 10
  s_add_u32 s84, s84, 65536
  buffer_load_dwordx2 v[8:9], v12, s[76:79], s84 offen sc1
Lnopoll_35:
  v_exp_f32 v32, v32
  v_exp_f32 v33, v33
  v_smfmac_f32_32x32x32_bf16 v[48:63], v[76:79], v[24:31], v2
  v_exp_f32 v34, v34
  v_exp_f32 v35, v35
  v_exp_f32 v36, v36
  s_waitcnt lgkmcnt(4)
  v_mfma_f32_32x32x16_bf16 v[16:31], v[64:67], v[112:115], 0
  ds_read_b128 v[68:71], v4 offset:7168
  v_exp_f32 v37, v37
  v_exp_f32 v38, v38
  v_exp_f32 v39, v39
  v_exp_f32 v40, v40
  v_exp_f32 v41, v41
  v_exp_f32 v42, v42
  v_exp_f32 v43, v43
  v_smfmac_f32_32x32x32_bf16 v[48:63], v[80:83], v[32:39], v2
  v_exp_f32 v44, v44
  v_exp_f32 v45, v45
  v_exp_f32 v46, v46
  v_exp_f32 v47, v47
  v_exp_f32 v16, v16
  v_exp_f32 v17, v17
  v_smfmac_f32_32x32x32_bf16 v[48:63], v[84:87], v[40:47], v2
  v_exp_f32 v18, v18
  v_exp_f32 v19, v19
  v_exp_f32 v20, v20
  s_waitcnt lgkmcnt(0)
  v_mfma_f32_32x32x16_bf16 v[32:47], v[68:71], v[112:115], 0
  v_exp_f32 v21, v21
  v_exp_f32 v22, v22
  v_exp_f32 v23, v23
  v_exp_f32 v24, v24
  v_exp_f32 v25, v25
  v_exp_f32 v26, v26
  v_exp_f32 v27, v27
  v_smfmac_f32_32x32x32_bf16 v[48:63], v[88:91], v[16:23], v2
  v_exp_f32 v28, v28
  v_exp_f32 v29, v29
  v_exp_f32 v30, v30
  v_exp_f32 v31, v31
  v_exp_f32 v32, v32
  v_exp_f32 v33, v33
  v_smfmac_f32_32x32x32_bf16 v[48:63], v[92:95], v[24:31], v2
  v_exp_f32 v34, v34
  v_exp_f32 v35, v35
  v_exp_f32 v36, v36
  s_waitcnt lgkmcnt(4)
  v_exp_f32 v37, v37
  v_exp_f32 v38, v38
  v_exp_f32 v39, v39
  v_exp_f32 v40, v40
  v_exp_f32 v41, v41
  v_exp_f32 v42, v42
  v_exp_f32 v43, v43
  v_smfmac_f32_32x32x32_bf16 v[48:63], v[96:99], v[32:39], v2
  v_exp_f32 v44, v44
  v_exp_f32 v45, v45
  v_exp_f32 v46, v46
  v_exp_f32 v47, v47
  s_nop 1
  v_smfmac_f32_32x32x32_bf16 v[48:63], v[100:103], v[40:47], v2
  v_add_u32 v4, 16384, v4
  v_add_u32 v5, 16384, v5
  v_mov_b32 v104, 0
Lown_33:
  s_cmp_lt_u32 s82, 4
  s_cbranch_scc1 Lnodma_37
  s_lshl_b32 s84, s81, 10
  s_add_u32 s84, s84, 65536
  s_mov_b32 s92, 0
  s_waitcnt vmcnt(0)
  v_cmp_ne_u32 s[88:89], s83, v9
Lmp_38:
  s_nop 0
  s_cmp_eq_u64 s[88:89], 0
  s_cbranch_scc1 Lmpd_39
  s_add_u32 s92, s92, 1
  s_cmp_ge_u32 s92, 40000
  s_cbranch_scc1 Lmpd_39
  s_sleep 1
  s_mov_b64 exec, s[88:89]
  s_cbranch_execz Lmps_40
  buffer_load_dwordx2 v[8:9], v12, s[76:79], s84 offen sc1
Lmps_40:
  s_waitcnt vmcnt(0)
  s_mov_b64 exec, s[88:89]
  v_cmp_ne_u32 s[88:89], s83, v9
  s_mov_b64 exec, -1
  s_branch Lmp_38
Lmpd_39:
  v_lshlrev_b32 v10, 4, v1
  s_and_b32 s86, s82, 3
  s_lshl_b32 s86, s86, 12
  s_lshl_b32 s87, s81, 17
  s_add_u32 s87, s87, 1048576
  s_add_u32 s87, s87, s86
  s_add_u32 s85, s80, 1
  s_and_b32 s85, s85, 7
  s_lshl_b32 s85, s85, 14
  s_add_u32 s85, s85, s87
  s_add_u32 m0, s86, 16384
  s_nop 0
  buffer_load_dwordx4 v10, s[76:79], s85 offen offset:0 sc1 lds
  buffer_load_dwordx4 v10, s[76:79], s85 offen offset:1024 sc1 lds
  buffer_load_dwordx4 v10, s[76:79], s85 offen offset:2048 sc1 lds
  buffer_load_dwordx4 v10, s[76:79], s85 offen offset:3072 sc1 lds
  v_max_f32_dpp v8, v8, v8 row_shr:1 row_mask:0xf bank_mask:0xf
  s_nop 1
  v_max_f32_dpp v8, v8, v8 row_shr:2 row_mask:0xf bank_mask:0xf
  s_nop 1
  v_max_f32_dpp v8, v8, v8 row_shr:4 row_mask:0xf bank_mask:0xf
  s_nop 1
  v_max_f32_dpp v8, v8, v8 row_shr:8 row_mask:0xf bank_mask:0xf
  s_nop 1
  v_max_f32_dpp v8, v8, v8 row_bcast:15 row_mask:0xa bank_mask:0xf
  v_mov_b32 v7, 160864
  s_mov_b32 exec_lo, 0x80000000
  s_mov_b32 exec_hi, 0x00000000
  ds_write_b32 v7, v8
  s_mov_b64 exec, -1
  s_add_u32 s85, s80, 2
  s_and_b32 s85, s85, 7
  s_lshl_b32 s85, s85, 14
  s_add_u32 s85, s85, s87
  s_add_u32 m0, s86, 32768
  s_nop 0
  buffer_load_dwordx4 v10, s[76:79], s85 offen offset:0 sc1 lds
  buffer_load_dwordx4 v10, s[76:79], s85 offen offset:1024 sc1 lds
  buffer_load_dwordx4 v10, s[76:79], s85 offen offset:2048 sc1 lds
  buffer_load_dwordx4 v10, s[76:79], s85 offen offset:3072 sc1 lds
  s_add_u32 s85, s80, 3
  s_and_b32 s85, s85, 7
  s_lshl_b32 s85, s85, 14
  s_add_u32 s85, s85, s87
  s_add_u32 m0, s86, 49152
  s_nop 0
  buffer_load_dwordx4 v10, s[76:79], s85 offen offset:0 sc1 lds
  buffer_load_dwordx4 v10, s[76:79], s85 offen offset:1024 sc1 lds
  buffer_load_dwordx4 v10, s[76:79], s85 offen offset:2048 sc1 lds
  buffer_load_dwordx4 v10, s[76:79], s85 offen offset:3072 sc1 lds
  s_add_u32 s85, s80, 4
  s_and_b32 s85, s85, 7
  s_lshl_b32 s85, s85, 14
  s_add_u32 s85, s85, s87
  s_add_u32 m0, s86, 65536
  s_nop 0
  buffer_load_dwordx4 v10, s[76:79], s85 offen offset:0 sc1 lds
  buffer_load_dwordx4 v10, s[76:79], s85 offen offset:1024 sc1 lds
  buffer_load_dwordx4 v10, s[76:79], s85 offen offset:2048 sc1 lds
  buffer_load_dwordx4 v10, s[76:79], s85 offen offset:3072 sc1 lds
Lnodma_37:
Lb1_36:
  s_waitcnt vmcnt(12) lgkmcnt(0)
  s_barrier
  v_mov_b32 v8, 160864
  ds_read_b32 v8, v8
  s_cmp_lg_u32 s94, 0
  s_cbranch_scc1 Lslow1_31
  ds_read_b128 v[64:67], v4 offset:0
  ds_read_b128 v[68:71], v4 offset:1024
  s_mov_b64 exec, s[96:97]
  ds_read_b128 v[72:75], v5 offset:0
  ds_read_b128 v[76:79], v5 offset:256
  ds_read_b128 v[80:83], v5 offset:1024
  ds_read_b128 v[84:87], v5 offset:1280
  s_mov_b64 exec, -1
  s_waitcnt lgkmcnt(6)
  v_readfirstlane_b32 s95, v8
  v_mov_b32 v8, s93
  s_nop 0
  v_mul_f32 v8, s95, v8
  v_mov_b32 v9, 0x45800000
  v_cmp_le_f32 vcc, v8, v9
  s_cbranch_vccz Lslow1_31
  s_waitcnt lgkmcnt(5)
  v_mfma_f32_32x32x16_bf16 v[16:31], v[64:67], v[112:115], 0
  s_mov_b32 s95, 1
  v_mov_b32 v40, 0
  v_mov_b32 v41, 0
  v_mov_b32 v42, 0
  v_mov_b32 v43, 0
  v_mov_b32 v44, 0
  v_mov_b32 v45, 0
  v_mov_b32 v46, 0
  v_mov_b32 v47, 0
  s_nop 3
  s_cmp_ge_u32 s82, 4
  s_cselect_b64 vcc, -1, 0
  s_branch Ltile_41
  .p2align 6
Ltile_41:
  v_exp_f32 v16, v16
  v_exp_f32 v17, v17
  v_smfmac_f32_32x32x32_bf16 v[48:63], v[100:103], v[40:47], v2
  v_exp_f32 v18, v18
  v_exp_f32 v19, v19
  v_exp_f32 v20, v20
  s_waitcnt lgkmcnt(0)
  v_mfma_f32_32x32x16_bf16 v[32:47], v[68:71], v[112:115], 0
  ds_read_b128 v[64:67], v4 offset:2048
  v_exp_f32 v21, v21
  v_exp_f32 v22, v22
  v_exp_f32 v23, v23
  v_exp_f32 v24, v24
  v_exp_f32 v25, v25
  v_exp_f32 v26, v26
  v_exp_f32 v27, v27
  v_smfmac_f32_32x32x32_bf16 v[48:63], v[72:75], v[16:23], v2
  s_mov_b64 exec, s[96:97]
  ds_read_b128 v[88:91], v5 offset:2048
  ds_read_b128 v[92:95], v5 offset:2304
  ds_read_b128 v[96:99], v5 offset:3072
  ds_read_b128 v[100:103], v5 offset:3328
  s_mov_b64 exec, -1
  v_exp_f32 v28, v28
  v_exp_f32 v29, v29
  v_exp_f32 v30, v30
  v_exp_f32 v31, v31
  v_exp_f32 v32, v32
  v_exp_f32 v33, v33
  v_smfmac_f32_32x32x32_bf16 v[48:63], v[76:79], v[24:31], v2
  v_exp_f32 v34, v34
  v_exp_f32 v35, v35
  v_exp_f32 v36, v36
  s_waitcnt lgkmcnt(4)
  v_mfma_f32_32x32x16_bf16 v[16:31], v[64:67], v[112:115], 0
  ds_read_b128 v[68:71], v4 offset:3072
  v_exp_f32 v37, v37
  v_exp_f32 v38, v38
  v_exp_f32 v39, v39
  v_exp_f32 v40, v40
  v_exp_f32 v41, v41
  v_exp_f32 v42, v42
  v_exp_f32 v43, v43
  v_smfmac_f32_32x32x32_bf16 v[48:63], v[80:83], v[32:39], v2
  v_exp_f32 v44, v44
  v_exp_f32 v45, v45
  v_exp_f32 v46, v46
  v_exp_f32 v47, v47
  s_cmp_eq_u32 s95, 2
  s_cbranch_scc1 Lhk_43
  s_cmp_eq_u32 s95, 3
  s_cbranch_scc1 Lhk_44
  s_cmp_eq_u32 s95, 4
  s_cbranch_scc1 Lhk_45
  s_cmp_eq_u32 s95, 5
  s_cbranch_scc1 Lhk_46
  s_cmp_eq_u32 s95, 6
  s_cbranch_scc1 Lhk_47
Lhb_42:
  v_exp_f32 v16, v16
  v_exp_f32 v17, v17
  v_smfmac_f32_32x32x32_bf16 v[48:63], v[84:87], v[40:47], v2
  v_exp_f32 v18, v18
  v_exp_f32 v19, v19
  v_exp_f32 v20, v20
  s_waitcnt lgkmcnt(0)
  v_mfma_f32_32x32x16_bf16 v[32:47], v[68:71], v[112:115], 0
  ds_read_b128 v[64:67], v4 offset:4096
  v_exp_f32 v21, v21
  v_exp_f32 v22, v22
  v_exp_f32 v23, v23
  v_exp_f32 v24, v24
  v_exp_f32 v25, v25
  v_exp_f32 v26, v26
  v_exp_f32 v27, v27
  v_smfmac_f32_32x32x32_bf16 v[48:63], v[88:91], v[16:23], v2
  s_mov_b64 exec, s[96:97]
  ds_read_b128 v[72:75], v5 offset:4096
  ds_read_b128 v[76:79], v5 offset:4352
  ds_read_b128 v[80:83], v5 offset:5120
  ds_read_b128 v[84:87], v5 offset:5376
  s_mov_b64 exec, -1
  v_exp_f32 v28, v28
  v_exp_f32 v29, v29
  v_exp_f32 v30, v30
  v_exp_f32 v31, v31
  s_cbranch_vccz Lpr_48
  s_setprio 0
Lpr_48:
  v_exp_f32 v32, v32
  v_exp_f32 v33, v33
  v_smfmac_f32_32x32x32_bf16 v[48:63], v[92:95], v[24:31], v2
  v_exp_f32 v34, v34
  v_exp_f32 v35, v35
  v_exp_f32 v36, v36
  s_waitcnt lgkmcnt(4)
  v_mfma_f32_32x32x16_bf16 v[16:31], v[64:67], v[112:115], 0
  ds_read_b128 v[68:71], v4 offset:5120
  v_exp_f32 v37, v37
  v_exp_f32 v38, v38
  v_exp_f32 v39, v39
  v_exp_f32 v40, v40
  v_exp_f32 v41, v41
  v_exp_f32 v42, v42
  v_exp_f32 v43, v43
  v_smfmac_f32_32x32x32_bf16 v[48:63], v[96:99], v[32:39], v2
  v_exp_f32 v44, v44
  v_exp_f32 v45, v45
  v_exp_f32 v46, v46
  v_exp_f32 v47, v47
  v_exp_f32 v16, v16
  v_exp_f32 v17, v17
  v_smfmac_f32_32x32x32_bf16 v[48:63], v[100:103], v[40:47], v2
  v_exp_f32 v18, v18
  v_exp_f32 v19, v19
  v_exp_f32 v20, v20
  s_waitcnt lgkmcnt(0)
  v_mfma_f32_32x32x16_bf16 v[32:47], v[68:71], v[112:115], 0
  ds_read_b128 v[64:67], v4 offset:6144
  v_exp_f32 v21, v21
  v_exp_f32 v22, v22
  v_exp_f32 v23, v23
  v_exp_f32 v24, v24
  v_exp_f32 v25, v25
  v_exp_f32 v26, v26
  v_exp_f32 v27, v27
  v_smfmac_f32_32x32x32_bf16 v[48:63], v[72:75], v[16:23], v2
  s_mov_b64 exec, s[96:97]
  ds_read_b128 v[88:91], v5 offset:6144
  ds_read_b128 v[92:95], v5 offset:6400
  ds_read_b128 v[96:99], v5 offset:7168
  ds_read_b128 v[100:103], v5 offset:7424
  s_mov_b64 exec, -1
  v_exp_f32 v28, v28
  v_exp_f32 v29, v29
  v_exp_f32 v30, v30
  v_exp_f32 v31, v31
  v_exp_f32 v32, v32
  v_exp_f32 v33, v33
  v_smfmac_f32_32x32x32_bf16 v[48:63], v[76:79], v[24:31], v2
  v_exp_f32 v34, v34
  v_exp_f32 v35, v35
  v_exp_f32 v36, v36
  s_waitcnt lgkmcnt(4)
  v_mfma_f32_32x32x16_bf16 v[16:31], v[64:67], v[112:115], 0
  ds_read_b128 v[68:71], v4 offset:7168
  v_exp_f32 v37, v37
  v_exp_f32 v38, v38
  v_exp_f32 v39, v39
  v_exp_f32 v40, v40
  v_exp_f32 v41, v41
  v_exp_f32 v42, v42
  v_exp_f32 v43, v43
  v_smfmac_f32_32x32x32_bf16 v[48:63], v[80:83], v[32:39], v2
  v_exp_f32 v44, v44
  v_exp_f32 v45, v45
  v_exp_f32 v46, v46
  v_exp_f32 v47, v47
  s_cbranch_vccz Lpr_49
  s_setprio 1
Lpr_49:
  s_cmp_eq_u32 s95, 1
  s_cbranch_scc1 Lhk_51
  s_cmp_eq_u32 s95, 2
  s_cbranch_scc1 Lhk_52
  s_cmp_eq_u32 s95, 3
  s_cbranch_scc1 Lhk_53
  s_cmp_eq_u32 s95, 4
  s_cbranch_scc1 Lhk_54
  s_cmp_eq_u32 s95, 5
  s_cbranch_scc1 Lhk_55
Lhb_50:
  v_exp_f32 v16, v16
  v_exp_f32 v17, v17
  v_smfmac_f32_32x32x32_bf16 v[48:63], v[84:87], v[40:47], v2
  v_exp_f32 v18, v18
  v_exp_f32 v19, v19
  v_exp_f32 v20, v20
  s_waitcnt lgkmcnt(0)
  v_mfma_f32_32x32x16_bf16 v[32:47], v[68:71], v[112:115], 0
  ds_read_b128 v[64:67], v4 offset:16384
  v_exp_f32 v21, v21
  v_exp_f32 v22, v22
  v_exp_f32 v23, v23
  v_exp_f32 v24, v24
  v_exp_f32 v25, v25
  v_exp_f32 v26, v26
  v_exp_f32 v27, v27
  v_smfmac_f32_32x32x32_bf16 v[48:63], v[88:91], v[16:23], v2
  s_mov_b64 exec, s[96:97]
  ds_read_b128 v[72:75], v5 offset:16384
  ds_read_b128 v[76:79], v5 offset:16640
  ds_read_b128 v[80:83], v5 offset:17408
  ds_read_b128 v[84:87], v5 offset:17664
  s_mov_b64 exec, -1
  v_exp_f32 v28, v28
  v_exp_f32 v29, v29
  v_exp_f32 v30, v30
  v_exp_f32 v31, v31
  v_exp_f32 v32, v32
  v_exp_f32 v33, v33
  v_smfmac_f32_32x32x32_bf16 v[48:63], v[92:95], v[24:31], v2
  v_exp_f32 v34, v34
  v_exp_f32 v35, v35
  v_exp_f32 v36, v36
  s_waitcnt lgkmcnt(4)
  v_mfma_f32_32x32x16_bf16 v[16:31], v[64:67], v[112:115], 0
  ds_read_b128 v[68:71], v4 offset:17408
  v_exp_f32 v37, v37
  v_exp_f32 v38, v38
  v_exp_f32 v39, v39
  v_exp_f32 v40, v40
  v_exp_f32 v41, v41
  v_exp_f32 v42, v42
  v_exp_f32 v43, v43
  v_smfmac_f32_32x32x32_bf16 v[48:63], v[96:99], v[32:39], v2
  v_exp_f32 v44, v44
  v_exp_f32 v45, v45
  v_exp_f32 v46, v46
  v_exp_f32 v47, v47
  v_add_u32 v4, 16384, v4
  v_add_u32 v5, 16384, v5
  s_add_u32 s95, s95, 1
  s_cmp_lt_u32 s95, 8
  s_cbranch_scc1 Ltile_41
  s_nop 1
  v_smfmac_f32_32x32x32_bf16 v[48:63], v[100:103], v[40:47], v2
  s_branch Lepi_32
Lhk_43:
  s_lshr_b32 s84, s99, 3
  s_lshl_b32 s85, s98, 2
  s_add_u32 s84, s84, s85
  s_lshl_b32 s84, s84, 2
  s_and_b32 s85, s82, 3
  s_add_u32 s84, s84, s85
  s_lshl_b32 s84, s84, 1
  s_lshr_b32 s86, s82, 2
  s_add_u32 s84, s84, s86
  s_lshl_b32 s84, s84, 13
  s_and_b32 s85, s99, 7
  s_lshl_b32 s85, s85, 7
  s_add_u32 s84, s84, s85
  v_and_b32 v6, 7, v1
  v_lshlrev_b32 v6, 10, v6
  v_bfe_u32 v7, v1, 3, 1
  v_lshl_add_u32 v6, v7, 6, v6
  v_bfe_u32 v7, v1, 4, 1
  v_lshl_add_u32 v6, v7, 5, v6
  v_lshrrev_b32 v7, 5, v1
  v_lshl_add_u32 v6, v7, 4, v6
  buffer_load_dwordx4 v[116:119], v6, s[36:39], s84 offen
  s_and_b32 s85, s99, 7
  s_lshl_b32 s85, s85, 7
  v_lshrrev_b32 v6, 6, v0
  v_and_b32 v6, 3, v6
  v_lshlrev_b32 v6, 12, v6
  v_lshl_add_u32 v6, v1, 3, v6
  s_lshl_b32 s84, s85, 2
  s_add_u32 s84, s84, 12288
  buffer_load_dwordx2 v[128:129], v6, s[76:79], s84 offen sc1
  v_lshlrev_b32 v6, 1, v1
  buffer_load_ushort v130, v6, s[48:51], s85 offen
  v_lshlrev_b32 v6, 1, v0
  buffer_load_ushort v131, v6, s[48:51], 0 offen
  v_lshlrev_b32 v6, 3, v0
  s_mov_b32 s84, 16384
  s_mov_b32 s86, 20480
  buffer_load_dwordx2 v[134:135], v6, s[76:79], s84 offen sc1
  buffer_load_dwordx2 v[132:133], v6, s[76:79], s86 offen sc1
  s_branch Lhb_42
Lhk_44:
  s_cmp_ge_u32 s99, 28
  s_cbranch_scc1 Lpf_56
  s_mul_i32 s84, s98, 28
  s_add_u32 s84, s84, s99
  s_lshl_b32 s84, s84, 4
  v_mul_u32_u24 v6, 3584, v0
  buffer_load_dwordx4 v[124:127], v6, s[56:59], s84 offen
Lpf_56:
  s_branch Lhb_42
Lhk_45:
  v_lshrrev_b32 v6, 3, v1
  v_bfe_u32 v7, v1, 4, 2
  v_lshlrev_b32 v7, 1, v7
  v_and_b32 v8, 7, v1
  v_xor_b32 v7, v7, v8
  v_lshlrev_b32 v7, 4, v7
  v_lshl_add_u32 v6, v6, 10, v7
  s_and_b32 s84, s99, 7
  s_lshl_b32 s84, s84, 7
  s_lshl_b32 s85, s82, 16
  s_add_u32 s84, s84, s85
  s_lshl_b32 s86, s82, 13
  s_add_u32 m0, s86, 4096
  s_add_u32 s85, s84, 32768
  buffer_load_dwordx4 v6, s[44:47], s85 offen lds
  s_add_u32 m0, s86, 5120
  s_add_u32 s85, s84, 40960
  buffer_load_dwordx4 v6, s[44:47], s85 offen lds
  s_add_u32 m0, s86, 6144
  s_add_u32 s85, s84, 49152
  buffer_load_dwordx4 v6, s[44:47], s85 offen lds
  s_add_u32 m0, s86, 7168
  s_add_u32 s85, s84, 57344
  buffer_load_dwordx4 v6, s[44:47], s85 offen lds
  s_branch Lhb_42
Lhk_46:
  s_cmp_lt_u32 s99, 24
  s_cbranch_scc1 Lpf_57
  s_lshl_b32 s84, s98, 3
  s_add_u32 s84, s84, s99
  s_sub_u32 s84, s84, 24
  s_lshl_b32 s84, s84, 4
  v_lshlrev_b32 v6, 10, v0
  v_add_u32 v6, 524288, v6
  buffer_load_dwordx4 v[244:247], v6, s[60:63], s84 offen
Lpf_57:
  s_branch Lhb_42
Lhk_47:
  s_cmp_lt_u32 s99, 24
  s_cbranch_scc1 Lpf_58
  s_lshl_b32 s84, s98, 3
  s_add_u32 s84, s84, s99
  s_sub_u32 s84, s84, 24
  s_lshl_b32 s84, s84, 4
  v_lshlrev_b32 v6, 10, v0
  v_add_u32 v6, 1572864, v6
  buffer_load_dwordx4 v[252:255], v6, s[60:63], s84 offen
Lpf_58:
  s_branch Lhb_42
Lhk_51:
  s_waitcnt vmcnt(0)
  s_barrier
  s_cmp_ge_u32 s82, 4
  s_cbranch_scc1 Lnodma_59
  v_lshlrev_b32 v10, 4, v1
  s_and_b32 s86, s82, 3
  s_lshl_b32 s86, s86, 12
  s_lshl_b32 s87, s81, 17
  s_add_u32 s87, s87, 1048576
  s_add_u32 s87, s87, s86
  s_add_u32 s85, s80, 5
  s_and_b32 s85, s85, 7
  s_lshl_b32 s85, s85, 14
  s_add_u32 s85, s85, s87
  s_add_u32 m0, s86, 81920
  s_nop 0
  buffer_load_dwordx4 v10, s[76:79], s85 offen offset:0 sc1 lds
  buffer_load_dwordx4 v10, s[76:79], s85 offen offset:1024 sc1 lds
  buffer_load_dwordx4 v10, s[76:79], s85 offen offset:2048 sc1 lds
  buffer_load_dwordx4 v10, s[76:79], s85 offen offset:3072 sc1 lds
  s_add_u32 s85, s80, 6
  s_and_b32 s85, s85, 7
  s_lshl_b32 s85, s85, 14
  s_add_u32 s85, s85, s87
  s_add_u32 m0, s86, 98304
  s_nop 0
  buffer_load_dwordx4 v10, s[76:79], s85 offen offset:0 sc1 lds
  buffer_load_dwordx4 v10, s[76:79], s85 offen offset:1024 sc1 lds
  buffer_load_dwordx4 v10, s[76:79], s85 offen offset:2048 sc1 lds
  buffer_load_dwordx4 v10, s[76:79], s85 offen offset:3072 sc1 lds
  s_add_u32 s85, s80, 7
  s_and_b32 s85, s85, 7
  s_lshl_b32 s85, s85, 14
  s_add_u32 s85, s85, s87
  s_add_u32 m0, s86, 114688
  s_nop 0
  buffer_load_dwordx4 v10, s[76:79], s85 offen offset:0 sc1 lds
  buffer_load_dwordx4 v10, s[76:79], s85 offen offset:1024 sc1 lds
  buffer_load_dwordx4 v10, s[76:79], s85 offen offset:2048 sc1 lds
  buffer_load_dwordx4 v10, s[76:79], s85 offen offset:3072 sc1 lds
Lnodma_59:
  s_branch Lhb_50
Lhk_52:
  s_cmp_ge_u32 s99, 28
  s_cbranch_scc1 Lpf_60
  s_mul_i32 s84, s98, 28
  s_add_u32 s84, s84, s99
  s_lshl_b32 s84, s84, 4
  v_mul_u32_u24 v6, 3584, v0
  buffer_load_dwordx4 v[120:123], v6, s[52:55], s84 offen
Lpf_60:
  s_branch Lhb_50
Lhk_53:
  s_waitcnt vmcnt(6) lgkmcnt(0)
  s_barrier
  v_lshrrev_b32 v6, 3, v1
  v_bfe_u32 v7, v1, 4, 2
  v_lshlrev_b32 v7, 1, v7
  v_and_b32 v8, 7, v1
  v_xor_b32 v7, v7, v8
  v_lshlrev_b32 v7, 4, v7
  v_lshl_add_u32 v6, v6, 10, v7
  s_and_b32 s84, s99, 7
  s_lshl_b32 s84, s84, 7
  s_lshl_b32 s85, s82, 16
  s_add_u32 s84, s84, s85
  s_lshl_b32 s86, s82, 13
  s_add_u32 m0, s86, 0
  s_add_u32 s85, s84, 0
  buffer_load_dwordx4 v6, s[44:47], s85 offen lds
  s_add_u32 m0, s86, 1024
  s_add_u32 s85, s84, 8192
  buffer_load_dwordx4 v6, s[44:47], s85 offen lds
  s_add_u32 m0, s86, 2048
  s_add_u32 s85, s84, 16384
  buffer_load_dwordx4 v6, s[44:47], s85 offen lds
  s_add_u32 m0, s86, 3072
  s_add_u32 s85, s84, 24576
  buffer_load_dwordx4 v6, s[44:47], s85 offen lds
  s_branch Lhb_50
Lhk_54:
  s_cmp_lt_u32 s99, 24
  s_cbranch_scc1 Lpf_61
  s_lshl_b32 s84, s98, 3
  s_add_u32 s84, s84, s99
  s_sub_u32 s84, s84, 24
  s_lshl_b32 s84, s84, 4
  v_lshlrev_b32 v6, 10, v0
  buffer_load_dwordx4 v[240:243], v6, s[60:63], s84 offen
Lpf_61:
  s_branch Lhb_50
Lhk_55:
  s_cmp_lt_u32 s99, 24
  s_cbranch_scc1 Lpf_62
  s_lshl_b32 s84, s98, 3
  s_add_u32 s84, s84, s99
  s_sub_u32 s84, s84, 24
  s_lshl_b32 s84, s84, 4
  v_lshlrev_b32 v6, 10, v0
  v_add_u32 v6, 1048576, v6
  buffer_load_dwordx4 v[248:251], v6, s[60:63], s84 offen
Lpf_62:
  s_branch Lhb_50
Lslow0_30:
  v_mov_b32 v104, 0xf149f2ca
  s_mov_b32 s94, 1
  s_mov_b32 s92, 8
Lslow_63:
  ds_read_b128 v[64:67], v4
  s_mov_b64 exec, s[96:97]
  ds_read_b128 v[72:75], v5
  ds_read_b128 v[76:79], v5 offset:256
  s_mov_b64 exec, -1
  s_waitcnt lgkmcnt(0)
  v_mfma_f32_32x32x16_bf16 v[16:31], v[64:67], v[112:115], 0
  s_nop 11
  v_max3_f32 v8, v16, v17, v104
  v_max3_f32 v8, v18, v19, v8
  v_max3_f32 v8, v20, v21, v8
  v_max3_f32 v8, v22, v23, v8
  v_max3_f32 v8, v24, v25, v8
  v_max3_f32 v8, v26, v27, v8
  v_max3_f32 v8, v28, v29, v8
  v_max3_f32 v8, v30, v31, v8
  v_mov_b32 v9, v8
  s_nop 1
  v_permlane32_swap_b32 v8, v9
  v_max_f32 v8, v8, v9
  v_sub_f32 v105, v104, v8
  v_exp_f32 v105, v105
  v_mov_b32 v104, v8
  v_sub_f32 v16, v16, v8
  v_exp_f32 v16, v16
  v_sub_f32 v17, v17, v8
  v_exp_f32 v17, v17
  v_sub_f32 v18, v18, v8
  v_exp_f32 v18, v18
  v_sub_f32 v19, v19, v8
  v_exp_f32 v19, v19
  v_sub_f32 v20, v20, v8
  v_exp_f32 v20, v20
  v_sub_f32 v21, v21, v8
  v_exp_f32 v21, v21
  v_sub_f32 v22, v22, v8
  v_exp_f32 v22, v22
  v_sub_f32 v23, v23, v8
  v_exp_f32 v23, v23
  v_sub_f32 v24, v24, v8
  v_exp_f32 v24, v24
  v_sub_f32 v25, v25, v8
  v_exp_f32 v25, v25
  v_sub_f32 v26, v26, v8
  v_exp_f32 v26, v26
  v_sub_f32 v27, v27, v8
  v_exp_f32 v27, v27
  v_sub_f32 v28, v28, v8
  v_exp_f32 v28, v28
  v_sub_f32 v29, v29, v8
  v_exp_f32 v29, v29
  v_sub_f32 v30, v30, v8
  v_exp_f32 v30, v30
  v_sub_f32 v31, v31, v8
  v_exp_f32 v31, v31
  v_mul_f32 v48, v48, v105
  v_mul_f32 v49, v49, v105
  v_mul_f32 v50, v50, v105
  v_mul_f32 v51, v51, v105
  v_mul_f32 v52, v52, v105
  v_mul_f32 v53, v53, v105
  v_mul_f32 v54, v54, v105
  v_mul_f32 v55, v55, v105
  v_mul_f32 v56, v56, v105
  v_mul_f32 v57, v57, v105
  v_mul_f32 v58, v58, v105
  v_mul_f32 v59, v59, v105
  v_mul_f32 v60, v60, v105
  v_mul_f32 v61, v61, v105
  v_mul_f32 v62, v62, v105
  v_mul_f32 v63, v63, v105
  s_nop 1
  v_smfmac_f32_32x32x32_bf16 v[48:63], v[72:75], v[16:23], v2
  v_smfmac_f32_32x32x32_bf16 v[48:63], v[76:79], v[24:31], v2
  s_sub_u32 s92, s92, 1
  s_and_b32 s84, s92, 7
  s_cmp_eq_u32 s84, 0
  s_cselect_b32 s84, 9, 1
  s_lshl_b32 s84, s84, 10
  v_add_u32 v4, s84, v4
  v_add_u32 v5, s84, v5
  s_cmp_lg_u32 s92, 0
  s_cbranch_scc1 Lslow_63
  s_cmp_lt_u32 s82, 4
  s_cbranch_scc1 Lnopoll_64
  s_lshl_b32 s84, s81, 10
  s_add_u32 s84, s84, 65536
  buffer_load_dwordx2 v[8:9], v12, s[76:79], s84 offen sc1
Lnopoll_64:
  s_branch Lown_33
Lslow1_31:
  s_mov_b32 s92, 8
Lslow_65:
  ds_read_b128 v[64:67], v4
  s_mov_b64 exec, s[96:97]
  ds_read_b128 v[72:75], v5
  ds_read_b128 v[76:79], v5 offset:256
  s_mov_b64 exec, -1
  s_waitcnt lgkmcnt(0)
  v_mfma_f32_32x32x16_bf16 v[16:31], v[64:67], v[112:115], 0
  s_nop 11
  v_max3_f32 v8, v16, v17, v104
  v_max3_f32 v8, v18, v19, v8
  v_max3_f32 v8, v20, v21, v8
  v_max3_f32 v8, v22, v23, v8
  v_max3_f32 v8, v24, v25, v8
  v_max3_f32 v8, v26, v27, v8
  v_max3_f32 v8, v28, v29, v8
  v_max3_f32 v8, v30, v31, v8
  v_mov_b32 v9, v8
  s_nop 1
  v_permlane32_swap_b32 v8, v9
  v_max_f32 v8, v8, v9
  v_sub_f32 v105, v104, v8
  v_exp_f32 v105, v105
  v_mov_b32 v104, v8
  v_sub_f32 v16, v16, v8
  v_exp_f32 v16, v16
  v_sub_f32 v17, v17, v8
  v_exp_f32 v17, v17
  v_sub_f32 v18, v18, v8
  v_exp_f32 v18, v18
  v_sub_f32 v19, v19, v8
  v_exp_f32 v19, v19
  v_sub_f32 v20, v20, v8
  v_exp_f32 v20, v20
  v_sub_f32 v21, v21, v8
  v_exp_f32 v21, v21
  v_sub_f32 v22, v22, v8
  v_exp_f32 v22, v22
  v_sub_f32 v23, v23, v8
  v_exp_f32 v23, v23
  v_sub_f32 v24, v24, v8
  v_exp_f32 v24, v24
  v_sub_f32 v25, v25, v8
  v_exp_f32 v25, v25
  v_sub_f32 v26, v26, v8
  v_exp_f32 v26, v26
  v_sub_f32 v27, v27, v8
  v_exp_f32 v27, v27
  v_sub_f32 v28, v28, v8
  v_exp_f32 v28, v28
  v_sub_f32 v29, v29, v8
  v_exp_f32 v29, v29
  v_sub_f32 v30, v30, v8
  v_exp_f32 v30, v30
  v_sub_f32 v31, v31, v8
  v_exp_f32 v31, v31
  v_mul_f32 v48, v48, v105
  v_mul_f32 v49, v49, v105
  v_mul_f32 v50, v50, v105
  v_mul_f32 v51, v51, v105
  v_mul_f32 v52, v52, v105
  v_mul_f32 v53, v53, v105
  v_mul_f32 v54, v54, v105
  v_mul_f32 v55, v55, v105
  v_mul_f32 v56, v56, v105
  v_mul_f32 v57, v57, v105
  v_mul_f32 v58, v58, v105
  v_mul_f32 v59, v59, v105
  v_mul_f32 v60, v60, v105
  v_mul_f32 v61, v61, v105
  v_mul_f32 v62, v62, v105
  v_mul_f32 v63, v63, v105
  s_nop 1
  v_smfmac_f32_32x32x32_bf16 v[48:63], v[72:75], v[16:23], v2
  v_smfmac_f32_32x32x32_bf16 v[48:63], v[76:79], v[24:31], v2
  s_sub_u32 s92, s92, 1
  s_and_b32 s84, s92, 7
  s_cmp_eq_u32 s84, 0
  s_cselect_b32 s84, 9, 1
  s_lshl_b32 s84, s84, 10
  v_add_u32 v4, s84, v4
  v_add_u32 v5, s84, v5
  s_cmp_lg_u32 s92, 0
  s_cbranch_scc1 Lslow_65
  s_waitcnt vmcnt(0)
  s_barrier
  s_cmp_ge_u32 s82, 4
  s_cbranch_scc1 Lnodma_66
  v_lshlrev_b32 v10, 4, v1
  s_and_b32 s86, s82, 3
  s_lshl_b32 s86, s86, 12
  s_lshl_b32 s87, s81, 17
  s_add_u32 s87, s87, 1048576
  s_add_u32 s87, s87, s86
  s_add_u32 s85, s80, 5
  s_and_b32 s85, s85, 7
  s_lshl_b32 s85, s85, 14
  s_add_u32 s85, s85, s87
  s_add_u32 m0, s86, 81920
  s_nop 0
  buffer_load_dwordx4 v10, s[76:79], s85 offen offset:0 sc1 lds
  buffer_load_dwordx4 v10, s[76:79], s85 offen offset:1024 sc1 lds
  buffer_load_dwordx4 v10, s[76:79], s85 offen offset:2048 sc1 lds
  buffer_load_dwordx4 v10, s[76:79], s85 offen offset:3072 sc1 lds
  s_add_u32 s85, s80, 6
  s_and_b32 s85, s85, 7
  s_lshl_b32 s85, s85, 14
  s_add_u32 s85, s85, s87
  s_add_u32 m0, s86, 98304
  s_nop 0
  buffer_load_dwordx4 v10, s[76:79], s85 offen offset:0 sc1 lds
  buffer_load_dwordx4 v10, s[76:79], s85 offen offset:1024 sc1 lds
  buffer_load_dwordx4 v10, s[76:79], s85 offen offset:2048 sc1 lds
  buffer_load_dwordx4 v10, s[76:79], s85 offen offset:3072 sc1 lds
  s_add_u32 s85, s80, 7
  s_and_b32 s85, s85, 7
  s_lshl_b32 s85, s85, 14
  s_add_u32 s85, s85, s87
  s_add_u32 m0, s86, 114688
  s_nop 0
  buffer_load_dwordx4 v10, s[76:79], s85 offen offset:0 sc1 lds
  buffer_load_dwordx4 v10, s[76:79], s85 offen offset:1024 sc1 lds
  buffer_load_dwordx4 v10, s[76:79], s85 offen offset:2048 sc1 lds
  buffer_load_dwordx4 v10, s[76:79], s85 offen offset:3072 sc1 lds
Lnodma_66:
  s_lshr_b32 s84, s99, 3
  s_lshl_b32 s85, s98, 2
  s_add_u32 s84, s84, s85
  s_lshl_b32 s84, s84, 2
  s_and_b32 s85, s82, 3
  s_add_u32 s84, s84, s85
  s_lshl_b32 s84, s84, 1
  s_lshr_b32 s86, s82, 2
  s_add_u32 s84, s84, s86
  s_lshl_b32 s84, s84, 13
  s_and_b32 s85, s99, 7
  s_lshl_b32 s85, s85, 7
  s_add_u32 s84, s84, s85
  v_and_b32 v6, 7, v1
  v_lshlrev_b32 v6, 10, v6
  v_bfe_u32 v7, v1, 3, 1
  v_lshl_add_u32 v6, v7, 6, v6
  v_bfe_u32 v7, v1, 4, 1
  v_lshl_add_u32 v6, v7, 5, v6
  v_lshrrev_b32 v7, 5, v1
  v_lshl_add_u32 v6, v7, 4, v6
  buffer_load_dwordx4 v[116:119], v6, s[36:39], s84 offen
  s_and_b32 s85, s99, 7
  s_lshl_b32 s85, s85, 7
  v_lshrrev_b32 v6, 6, v0
  v_and_b32 v6, 3, v6
  v_lshlrev_b32 v6, 12, v6
  v_lshl_add_u32 v6, v1, 3, v6
  s_lshl_b32 s84, s85, 2
  s_add_u32 s84, s84, 12288
  buffer_load_dwordx2 v[128:129], v6, s[76:79], s84 offen sc1
  v_lshlrev_b32 v6, 1, v1
  buffer_load_ushort v130, v6, s[48:51], s85 offen
  v_lshlrev_b32 v6, 1, v0
  buffer_load_ushort v131, v6, s[48:51], 0 offen
  v_lshlrev_b32 v6, 3, v0
  s_mov_b32 s84, 16384
  s_mov_b32 s86, 20480
  buffer_load_dwordx2 v[134:135], v6, s[76:79], s84 offen sc1
  buffer_load_dwordx2 v[132:133], v6, s[76:79], s86 offen sc1
  s_cmp_ge_u32 s99, 28
  s_cbranch_scc1 Lpf_67
  s_mul_i32 s84, s98, 28
  s_add_u32 s84, s84, s99
  s_lshl_b32 s84, s84, 4
  v_mul_u32_u24 v6, 3584, v0
  buffer_load_dwordx4 v[120:123], v6, s[52:55], s84 offen
Lpf_67:
  s_cmp_ge_u32 s99, 28
  s_cbranch_scc1 Lpf_68
  s_mul_i32 s84, s98, 28
  s_add_u32 s84, s84, s99
  s_lshl_b32 s84, s84, 4
  v_mul_u32_u24 v6, 3584, v0
  buffer_load_dwordx4 v[124:127], v6, s[56:59], s84 offen
Lpf_68:
  s_cmp_lt_u32 s99, 24
  s_cbranch_scc1 Lpf_69
  s_lshl_b32 s84, s98, 3
  s_add_u32 s84, s84, s99
  s_sub_u32 s84, s84, 24
  s_lshl_b32 s84, s84, 4
  v_lshlrev_b32 v6, 10, v0
  buffer_load_dwordx4 v[240:243], v6, s[60:63], s84 offen
Lpf_69:
  s_cmp_lt_u32 s99, 24
  s_cbranch_scc1 Lpf_70
  s_lshl_b32 s84, s98, 3
  s_add_u32 s84, s84, s99
  s_sub_u32 s84, s84, 24
  s_lshl_b32 s84, s84, 4
  v_lshlrev_b32 v6, 10, v0
  v_add_u32 v6, 524288, v6
  buffer_load_dwordx4 v[244:247], v6, s[60:63], s84 offen
Lpf_70:
  s_cmp_lt_u32 s99, 24
  s_cbranch_scc1 Lpf_71
  s_lshl_b32 s84, s98, 3
  s_add_u32 s84, s84, s99
  s_sub_u32 s84, s84, 24
  s_lshl_b32 s84, s84, 4
  v_lshlrev_b32 v6, 10, v0
  v_add_u32 v6, 1048576, v6
  buffer_load_dwordx4 v[248:251], v6, s[60:63], s84 offen
Lpf_71:
  s_cmp_lt_u32 s99, 24
  s_cbranch_scc1 Lpf_72
  s_lshl_b32 s84, s98, 3
  s_add_u32 s84, s84, s99
  s_sub_u32 s84, s84, 24
  s_lshl_b32 s84, s84, 4
  v_lshlrev_b32 v6, 10, v0
  v_add_u32 v6, 1572864, v6
  buffer_load_dwordx4 v[252:255], v6, s[60:63], s84 offen
Lpf_72:
  s_mov_b32 s92, 16
Lslow_73:
  ds_read_b128 v[64:67], v4
  s_mov_b64 exec, s[96:97]
  ds_read_b128 v[72:75], v5
  ds_read_b128 v[76:79], v5 offset:256
  s_mov_b64 exec, -1
  s_waitcnt lgkmcnt(0)
  v_mfma_f32_32x32x16_bf16 v[16:31], v[64:67], v[112:115], 0
  s_nop 11
  v_max3_f32 v8, v16, v17, v104
  v_max3_f32 v8, v18, v19, v8
  v_max3_f32 v8, v20, v21, v8
  v_max3_f32 v8, v22, v23, v8
  v_max3_f32 v8, v24, v25, v8
  v_max3_f32 v8, v26, v27, v8
  v_max3_f32 v8, v28, v29, v8
  v_max3_f32 v8, v30, v31, v8
  v_mov_b32 v9, v8
  s_nop 1
  v_permlane32_swap_b32 v8, v9
  v_max_f32 v8, v8, v9
  v_sub_f32 v105, v104, v8
  v_exp_f32 v105, v105
  v_mov_b32 v104, v8
  v_sub_f32 v16, v16, v8
  v_exp_f32 v16, v16
  v_sub_f32 v17, v17, v8
  v_exp_f32 v17, v17
  v_sub_f32 v18, v18, v8
  v_exp_f32 v18, v18
  v_sub_f32 v19, v19, v8
  v_exp_f32 v19, v19
  v_sub_f32 v20, v20, v8
  v_exp_f32 v20, v20
  v_sub_f32 v21, v21, v8
  v_exp_f32 v21, v21
  v_sub_f32 v22, v22, v8
  v_exp_f32 v22, v22
  v_sub_f32 v23, v23, v8
  v_exp_f32 v23, v23
  v_sub_f32 v24, v24, v8
  v_exp_f32 v24, v24
  v_sub_f32 v25, v25, v8
  v_exp_f32 v25, v25
  v_sub_f32 v26, v26, v8
  v_exp_f32 v26, v26
  v_sub_f32 v27, v27, v8
  v_exp_f32 v27, v27
  v_sub_f32 v28, v28, v8
  v_exp_f32 v28, v28
  v_sub_f32 v29, v29, v8
  v_exp_f32 v29, v29
  v_sub_f32 v30, v30, v8
  v_exp_f32 v30, v30
  v_sub_f32 v31, v31, v8
  v_exp_f32 v31, v31
  v_mul_f32 v48, v48, v105
  v_mul_f32 v49, v49, v105
  v_mul_f32 v50, v50, v105
  v_mul_f32 v51, v51, v105
  v_mul_f32 v52, v52, v105
  v_mul_f32 v53, v53, v105
  v_mul_f32 v54, v54, v105
  v_mul_f32 v55, v55, v105
  v_mul_f32 v56, v56, v105
  v_mul_f32 v57, v57, v105
  v_mul_f32 v58, v58, v105
  v_mul_f32 v59, v59, v105
  v_mul_f32 v60, v60, v105
  v_mul_f32 v61, v61, v105
  v_mul_f32 v62, v62, v105
  v_mul_f32 v63, v63, v105
  s_nop 1
  v_smfmac_f32_32x32x32_bf16 v[48:63], v[72:75], v[16:23], v2
  v_smfmac_f32_32x32x32_bf16 v[48:63], v[76:79], v[24:31], v2
  s_sub_u32 s92, s92, 1
  s_and_b32 s84, s92, 7
  s_cmp_eq_u32 s84, 0
  s_cselect_b32 s84, 9, 1
  s_lshl_b32 s84, s84, 10
  v_add_u32 v4, s84, v4
  v_add_u32 v5, s84, v5
  s_cmp_lg_u32 s92, 0
  s_cbranch_scc1 Lslow_73
  s_waitcnt vmcnt(0) lgkmcnt(0)
  s_barrier
  v_lshrrev_b32 v6, 3, v1
  v_bfe_u32 v7, v1, 4, 2
  v_lshlrev_b32 v7, 1, v7
  v_and_b32 v8, 7, v1
  v_xor_b32 v7, v7, v8
  v_lshlrev_b32 v7, 4, v7
  v_lshl_add_u32 v6, v6, 10, v7
  s_and_b32 s84, s99, 7
  s_lshl_b32 s84, s84, 7
  s_lshl_b32 s85, s82, 16
  s_add_u32 s84, s84, s85
  s_lshl_b32 s86, s82, 13
  s_add_u32 m0, s86, 0
  s_add_u32 s85, s84, 0
  buffer_load_dwordx4 v6, s[44:47], s85 offen lds
  s_add_u32 m0, s86, 1024
  s_add_u32 s85, s84, 8192
  buffer_load_dwordx4 v6, s[44:47], s85 offen lds
  s_add_u32 m0, s86, 2048
  s_add_u32 s85, s84, 16384
  buffer_load_dwordx4 v6, s[44:47], s85 offen lds
  s_add_u32 m0, s86, 3072
  s_add_u32 s85, s84, 24576
  buffer_load_dwordx4 v6, s[44:47], s85 offen lds
  s_add_u32 m0, s86, 4096
  s_add_u32 s85, s84, 32768
  buffer_load_dwordx4 v6, s[44:47], s85 offen lds
  s_add_u32 m0, s86, 5120
  s_add_u32 s85, s84, 40960
  buffer_load_dwordx4 v6, s[44:47], s85 offen lds
  s_add_u32 m0, s86, 6144
  s_add_u32 s85, s84, 49152
  buffer_load_dwordx4 v6, s[44:47], s85 offen lds
  s_add_u32 m0, s86, 7168
  s_add_u32 s85, s84, 57344
  buffer_load_dwordx4 v6, s[44:47], s85 offen lds
  s_mov_b32 s92, 32
Lslow_74:
  ds_read_b128 v[64:67], v4
  s_mov_b64 exec, s[96:97]
  ds_read_b128 v[72:75], v5
  ds_read_b128 v[76:79], v5 offset:256
  s_mov_b64 exec, -1
  s_waitcnt lgkmcnt(0)
  v_mfma_f32_32x32x16_bf16 v[16:31], v[64:67], v[112:115], 0
  s_nop 11
  v_max3_f32 v8, v16, v17, v104
  v_max3_f32 v8, v18, v19, v8
  v_max3_f32 v8, v20, v21, v8
  v_max3_f32 v8, v22, v23, v8
  v_max3_f32 v8, v24, v25, v8
  v_max3_f32 v8, v26, v27, v8
  v_max3_f32 v8, v28, v29, v8
  v_max3_f32 v8, v30, v31, v8
  v_mov_b32 v9, v8
  s_nop 1
  v_permlane32_swap_b32 v8, v9
  v_max_f32 v8, v8, v9
  v_sub_f32 v105, v104, v8
  v_exp_f32 v105, v105
  v_mov_b32 v104, v8
  v_sub_f32 v16, v16, v8
  v_exp_f32 v16, v16
  v_sub_f32 v17, v17, v8
  v_exp_f32 v17, v17
  v_sub_f32 v18, v18, v8
  v_exp_f32 v18, v18
  v_sub_f32 v19, v19, v8
  v_exp_f32 v19, v19
  v_sub_f32 v20, v20, v8
  v_exp_f32 v20, v20
  v_sub_f32 v21, v21, v8
  v_exp_f32 v21, v21
  v_sub_f32 v22, v22, v8
  v_exp_f32 v22, v22
  v_sub_f32 v23, v23, v8
  v_exp_f32 v23, v23
  v_sub_f32 v24, v24, v8
  v_exp_f32 v24, v24
  v_sub_f32 v25, v25, v8
  v_exp_f32 v25, v25
  v_sub_f32 v26, v26, v8
  v_exp_f32 v26, v26
  v_sub_f32 v27, v27, v8
  v_exp_f32 v27, v27
  v_sub_f32 v28, v28, v8
  v_exp_f32 v28, v28
  v_sub_f32 v29, v29, v8
  v_exp_f32 v29, v29
  v_sub_f32 v30, v30, v8
  v_exp_f32 v30, v30
  v_sub_f32 v31, v31, v8
  v_exp_f32 v31, v31
  v_mul_f32 v48, v48, v105
  v_mul_f32 v49, v49, v105
  v_mul_f32 v50, v50, v105
  v_mul_f32 v51, v51, v105
  v_mul_f32 v52, v52, v105
  v_mul_f32 v53, v53, v105
  v_mul_f32 v54, v54, v105
  v_mul_f32 v55, v55, v105
  v_mul_f32 v56, v56, v105
  v_mul_f32 v57, v57, v105
  v_mul_f32 v58, v58, v105
  v_mul_f32 v59, v59, v105
  v_mul_f32 v60, v60, v105
  v_mul_f32 v61, v61, v105
  v_mul_f32 v62, v62, v105
  v_mul_f32 v63, v63, v105
  s_nop 1
  v_smfmac_f32_32x32x32_bf16 v[48:63], v[72:75], v[16:23], v2
  v_smfmac_f32_32x32x32_bf16 v[48:63], v[76:79], v[24:31], v2
  s_sub_u32 s92, s92, 1
  s_and_b32 s84, s92, 7
  s_cmp_eq_u32 s84, 0
  s_cselect_b32 s84, 9, 1
  s_lshl_b32 s84, s84, 10
  v_add_u32 v4, s84, v4
  v_add_u32 v5, s84, v5
  s_cmp_lg_u32 s92, 0
  s_cbranch_scc1 Lslow_74
Lepi_32:
  s_waitcnt lgkmcnt(0)
  s_setprio 0
  s_nop 8
  v_mov_b32 v9, v56
  v_mov_b32 v8, v56
  s_nop 1
  v_permlane32_swap_b32 v8, v9
  v_rcp_f32 v8, v8
  s_and_b32 s85, s82, 3
  s_lshl_b32 s85, s85, 1
  s_bitcmp1_b32 s82, 2
  s_addc_u32 s85, s85, 0
  s_lshl_b32 s84, s80, 3
  s_add_u32 s84, s84, s85
  s_lshl_b32 s85, s84, 15
  s_lshl_b32 s86, s81, 9
  s_add_u32 s85, s85, s86
  s_add_u32 s85, s85, 5242880
  v_bfe_u32 v6, v1, 4, 1
  v_lshlrev_b32 v6, 14, v6
  v_lshrrev_b32 v7, 5, v1
  v_lshl_add_u32 v6, v7, 8, v6
  v_and_b32 v7, 15, v1
  v_lshl_add_u32 v6, v7, 4, v6
  v_mul_f32 v48, v48, v8
  v_mul_f32 v49, v49, v8
  v_mul_f32 v50, v50, v8
  v_mul_f32 v51, v51, v8
  v_mul_f32 v52, v52, v8
  v_mul_f32 v53, v53, v8
  v_mul_f32 v54, v54, v8
  v_mul_f32 v55, v55, v8
  v_cvt_pk_bf16_f32 v8, v48, v49
  v_cvt_pk_bf16_f32 v9, v50, v51
  v_cvt_pk_bf16_f32 v10, v52, v53
  v_cvt_pk_bf16_f32 v11, v54, v55
  buffer_store_dwordx4 v[8:11], v6, s[76:79], s85 offen sc1
  s_waitcnt vmcnt(1)
  s_mov_b32 s92, 0
Lmodp_76:
  v_cmp_ne_u32 s[8:9], s83, v129
  v_cmp_ne_u32 vcc, s83, v133
  s_nop 0
  s_or_b64 s[8:9], s[8:9], vcc
  v_cmp_ne_u32 vcc, s83, v135
  s_nop 0
  s_or_b64 vcc, s[8:9], vcc
  s_cbranch_vccz Lmodok_75
  s_and_b32 s85, s99, 7
  s_lshl_b32 s85, s85, 7
  v_lshrrev_b32 v6, 6, v0
  v_and_b32 v6, 3, v6
  v_lshlrev_b32 v6, 12, v6
  v_lshl_add_u32 v6, v1, 3, v6
  s_lshl_b32 s84, s85, 2
  s_add_u32 s84, s84, 12288
  buffer_load_dwordx2 v[128:129], v6, s[76:79], s84 offen sc1
  v_lshlrev_b32 v6, 1, v1
  buffer_load_ushort v130, v6, s[48:51], s85 offen
  v_lshlrev_b32 v6, 1, v0
  buffer_load_ushort v131, v6, s[48:51], 0 offen
  v_lshlrev_b32 v6, 3, v0
  s_mov_b32 s84, 16384
  s_mov_b32 s86, 20480
  buffer_load_dwordx2 v[134:135], v6, s[76:79], s84 offen sc1
  buffer_load_dwordx2 v[132:133], v6, s[76:79], s86 offen sc1
  s_waitcnt vmcnt(0)
  s_add_u32 s92, s92, 1
  s_cmp_lt_u32 s92, 40000
  s_cbranch_scc1 Lmodp_76
Lmodok_75:
  v_lshlrev_b32 v131, 16, v131
  v_add_f32 v6, 1.0, v132
  v_mul_f32 v6, v6, v131
  v_mul_f32 v7, v134, v131
  s_nop 1
  v_permlane32_swap_b32 v6, v7
  v_add_f32 v6, v6, v7
  s_nop 1
  v_add_f32_dpp v6, v6, v6 row_shr:1 row_mask:0xf bank_mask:0xf
  s_nop 1
  v_add_f32_dpp v6, v6, v6 row_shr:2 row_mask:0xf bank_mask:0xf
  s_nop 1
  v_add_f32_dpp v6, v6, v6 row_shr:4 row_mask:0xf bank_mask:0xf
  s_nop 1
  v_add_f32_dpp v6, v6, v6 row_shr:8 row_mask:0xf bank_mask:0xf
  s_nop 1
  v_add_f32_dpp v6, v6, v6 row_bcast:15 row_mask:0xa bank_mask:0xf
  v_lshrrev_b32 v7, 5, v1
  v_lshlrev_b32 v7, 2, v7
  s_lshl_b32 s84, s82, 3
  s_add_u32 s84, s84, 162304
  v_add_u32 v7, s84, v7
  s_mov_b32 exec_lo, 0x80000000
  s_mov_b32 exec_hi, 0x80000000
  ds_write_b32 v7, v6
  s_mov_b64 exec, -1
  s_cmp_ge_u32 s82, 4
  s_cbranch_scc1 Ltb_77
  s_lshl_b32 s84, s82, 8
  s_add_u32 s84, s84, 161024
  v_lshl_add_u32 v7, v1, 2, s84
  s_cmp_lg_u32 s82, 2
  s_cbranch_scc1 Ltb_78
  v_add_f32 v128, 1.0, v128
  v_lshlrev_b32 v8, 16, v130
  v_mul_f32 v8, v8, v128
  ds_write_b32 v7, v8 offset:512
Ltb_78:
  ds_write_b32 v7, v128
Ltb_77:
  s_lshr_b32 s93, s99, 3
  s_lshl_b32 s84, s98, 2
  s_add_u32 s93, s93, s84
  s_and_b32 s91, s82, 3
  s_lshr_b32 s96, s82, 2
  s_lshl_b32 s94, s93, 2
  s_add_u32 s94, s94, s91
  s_lshl_b32 s41, s94, 14
  s_lshl_b32 s84, s96, 13
  s_add_u32 s41, s41, s84
  s_add_u32 s41, s41, 5242880
  s_lshr_b32 s42, s94, 1
  s_lshl_b32 s42, s42, 7
  s_add_u32 s42, s42, 12582912
  s_lshl_b32 s94, s94, 1
  s_add_u32 s94, s94, s96
  s_and_b32 s95, s99, 7
  v_lshlrev_b32 v6, 2, v1
  v_lshlrev_b32 v5, 4, v1
  v_lshrrev_b32 v8, 4, v1
  v_bfe_u32 v9, v1, 2, 2
  v_and_b32 v10, 3, v1
  v_lshrrev_b32 v11, 1, v8
  v_lshlrev_b32 v11, 4, v11
  v_and_b32 v2, 1, v8
  v_lshl_add_u32 v11, v2, 2, v11
  v_add_u32 v11, v11, v9
  v_lshlrev_b32 v3, 1, v2
  v_lshrrev_b32 v4, 1, v9
  v_add_u32 v3, v3, v4
  v_lshlrev_b32 v3, 1, v3
  v_lshrrev_b32 v4, 1, v10
  v_xor_b32 v4, v4, v3
  v_lshlrev_b32 v4, 4, v4
  v_and_b32 v10, 1, v10
  v_lshl_add_u32 v4, v10, 3, v4
  v_lshl_add_u32 v10, v11, 7, v4
  s_lshl_b32 s85, s96, 15
  v_add_u32 v48, s85, v10
  v_xor_b32 v49, 32, v48
  v_xor_b32 v50, 64, v48
  v_xor_b32 v51, 96, v48
  v_bfe_u32 v2, v1, 3, 1
  v_lshlrev_b32 v2, 7, v2
  v_lshl_add_u32 v7, v8, 4, v2
  v_add_u32 v7, 161024, v7
  s_and_b32 s85, s82, 3
  s_lshl_b32 s85, s85, 1
  s_bitcmp1_b32 s82, 2
  s_addc_u32 s85, s85, 0
  s_lshl_b32 s84, s80, 3
  s_add_u32 s84, s84, s85
  s_lshl_b32 s84, s84, 5
  s_add_u32 s84, s84, s81
  s_lshl_b32 s84, s84, 2
  s_add_u32 s84, s84, 12582912
  v_mov_b32 v12, s83
  v_mov_b32 v13, 0
  s_and_b32 s85, s82, 2
  s_lshl_b32 s85, s85, 1
  s_add_u32 s85, s85, 160848
  v_mov_b32 v8, s85
  s_and_b32 s44, s82, 5
  v_mov_b32 v64, 0
  v_mov_b32 v65, 0
  v_mov_b32 v66, 0
  v_mov_b32 v67, 0
  v_mov_b32 v68, 0
  v_mov_b32 v69, 0
  v_mov_b32 v70, 0
  v_mov_b32 v71, 0
  v_mov_b32 v72, 0
  v_mov_b32 v73, 0
  v_mov_b32 v74, 0
  v_mov_b32 v75, 0
  v_mov_b32 v76, 0
  v_mov_b32 v77, 0
  v_mov_b32 v78, 0
  v_mov_b32 v79, 0
  s_mov_b32 s36, 0
  s_mov_b32 s37, 0
  s_mov_b32 s92, 0
  s_mov_b32 s38, 0
  s_lshl_b32 s46, s96, 4
  s_waitcnt vmcnt(0)
  s_mov_b32 exec_lo, 0x00000001
  s_mov_b32 exec_hi, 0x00000000
  buffer_store_dword v12, v13, s[76:79], s84 offen sc1
  v_mov_b32 v2, 160844
  v_mov_b32 v3, 1
  ds_add_u32 v2, v3
  s_mov_b64 exec, -1
  s_cmp_eq_u32 s44, 4
  s_cbranch_scc1 Lpol_79
  ds_read_b32 v9, v8
  s_waitcnt lgkmcnt(0)
  v_readfirstlane_b32 s36, v9
  s_nop 0
  s_lshr_b32 s85, s36, s46
  s_bitcmp1_b32 s37, 0
  s_cbranch_scc1 Lgl_81
  s_andn2_b32 s84, 0x00000303, s85
  s_cbranch_scc1 Lgl_81
  s_bitset1_b32 s37, 0
  s_mov_b32 s38, 0
  s_add_u32 s84, s41, 0
  buffer_load_dwordx4 v[16:19], v5, s[76:79], s84 offen sc1
  s_add_u32 s84, s41, 4096
  buffer_load_dwordx4 v[32:35], v5, s[76:79], s84 offen sc1
Lgl_81:
  s_bitcmp1_b32 s37, 1
  s_cbranch_scc1 Lgl_82
  s_andn2_b32 s84, 0x00000c0c, s85
  s_cbranch_scc1 Lgl_82
  s_bitset1_b32 s37, 1
  s_mov_b32 s38, 1
  s_add_u32 s84, s41, 1024
  buffer_load_dwordx4 v[20:23], v5, s[76:79], s84 offen sc1
  s_add_u32 s84, s41, 5120
  buffer_load_dwordx4 v[36:39], v5, s[76:79], s84 offen sc1
Lgl_82:
  s_bitcmp1_b32 s37, 2
  s_cbranch_scc1 Lgl_83
  s_andn2_b32 s84, 0x00003030, s85
  s_cbranch_scc1 Lgl_83
  s_bitset1_b32 s37, 2
  s_mov_b32 s38, 2
  s_add_u32 s84, s41, 2048
  buffer_load_dwordx4 v[24:27], v5, s[76:79], s84 offen sc1
  s_add_u32 s84, s41, 6144
  buffer_load_dwordx4 v[40:43], v5, s[76:79], s84 offen sc1
Lgl_83:
  s_bitcmp1_b32 s37, 3
  s_cbranch_scc1 Lgl_84
  s_andn2_b32 s84, 0x0000c0c0, s85
  s_cbranch_scc1 Lgl_84
  s_bitset1_b32 s37, 3
  s_mov_b32 s38, 3
  s_add_u32 s84, s41, 3072
  buffer_load_dwordx4 v[28:31], v5, s[76:79], s84 offen sc1
  s_add_u32 s84, s41, 7168
  buffer_load_dwordx4 v[44:47], v5, s[76:79], s84 offen sc1
Lgl_84:
  v_mov_b32 v2, 160844
  s_mov_b32 s92, 0
Lwo_85:
  ds_read_b32 v3, v2
  s_waitcnt lgkmcnt(0)
  v_readfirstlane_b32 s84, v3
  s_add_u32 s92, s92, 1
  s_cmp_ge_u32 s92, 40000
  s_cselect_b32 s84, 8, s84
  s_cmp_lt_u32 s84, 8
  s_cbranch_scc1 Lwo_85
  v_and_b32 v2, 7, v1
  v_lshlrev_b32 v2, 3, v2
  v_add_u32 v2, 162304, v2
  ds_read_b64 v[2:3], v2
  ds_read_b128 v[80:83], v7 offset:0
  ds_read_b128 v[88:91], v7 offset:1024
  ds_read_b128 v[84:87], v7 offset:64
  ds_read_b128 v[92:95], v7 offset:1088
  s_waitcnt lgkmcnt(4)
  v_add_f32_dpp v2, v2, v2 row_shr:1 row_mask:0xf bank_mask:0xf
  v_add_f32_dpp v3, v3, v3 row_shr:1 row_mask:0xf bank_mask:0xf
  s_nop 0
  v_add_f32_dpp v2, v2, v2 row_shr:2 row_mask:0xf bank_mask:0xf
  v_add_f32_dpp v3, v3, v3 row_shr:2 row_mask:0xf bank_mask:0xf
  s_nop 0
  v_add_f32_dpp v2, v2, v2 row_shr:4 row_mask:0xf bank_mask:0xf
  v_add_f32_dpp v3, v3, v3 row_shr:4 row_mask:0xf bank_mask:0xf
  v_readlane_b32 s39, v2, 7
  v_readlane_b32 s40, v3, 7
  ds_read_b64_tr_b16 v[128:129], v48 offset:0
  ds_read_b64_tr_b16 v[130:131], v48 offset:1024
  ds_read_b64_tr_b16 v[132:133], v49 offset:0
  ds_read_b64_tr_b16 v[134:135], v49 offset:1024
  ds_read_b64_tr_b16 v[136:137], v50 offset:0
  ds_read_b64_tr_b16 v[138:139], v50 offset:1024
  ds_read_b64_tr_b16 v[140:141], v51 offset:0
  ds_read_b64_tr_b16 v[142:143], v51 offset:1024
  ds_read_b64_tr_b16 v[144:145], v48 offset:4096
  ds_read_b64_tr_b16 v[146:147], v48 offset:5120
  ds_read_b64_tr_b16 v[148:149], v49 offset:4096
  ds_read_b64_tr_b16 v[150:151], v49 offset:5120
  ds_read_b64_tr_b16 v[152:153], v50 offset:4096
  ds_read_b64_tr_b16 v[154:155], v50 offset:5120
  ds_read_b64_tr_b16 v[156:157], v51 offset:4096
  ds_read_b64_tr_b16 v[158:159], v51 offset:5120
  ds_read_b64_tr_b16 v[160:161], v48 offset:8192
  ds_read_b64_tr_b16 v[162:163], v48 offset:9216
  ds_read_b64_tr_b16 v[164:165], v49 offset:8192
  ds_read_b64_tr_b16 v[166:167], v49 offset:9216
  ds_read_b64_tr_b16 v[168:169], v50 offset:8192
  ds_read_b64_tr_b16 v[170:171], v50 offset:9216
  ds_read_b64_tr_b16 v[172:173], v51 offset:8192
  ds_read_b64_tr_b16 v[174:175], v51 offset:9216
  ds_read_b64_tr_b16 v[176:177], v48 offset:12288
  ds_read_b64_tr_b16 v[178:179], v48 offset:13312
  ds_read_b64_tr_b16 v[180:181], v49 offset:12288
  ds_read_b64_tr_b16 v[182:183], v49 offset:13312
  ds_read_b64_tr_b16 v[184:185], v50 offset:12288
  ds_read_b64_tr_b16 v[186:187], v50 offset:13312
  ds_read_b64_tr_b16 v[188:189], v51 offset:12288
  ds_read_b64_tr_b16 v[190:191], v51 offset:13312
  ds_read_b64_tr_b16 v[192:193], v48 offset:16384
  ds_read_b64_tr_b16 v[194:195], v48 offset:17408
  ds_read_b64_tr_b16 v[196:197], v49 offset:16384
  ds_read_b64_tr_b16 v[198:199], v49 offset:17408
  ds_read_b64_tr_b16 v[200:201], v50 offset:16384
  ds_read_b64_tr_b16 v[202:203], v50 offset:17408
  ds_read_b64_tr_b16 v[204:205], v51 offset:16384
  ds_read_b64_tr_b16 v[206:207], v51 offset:17408
  ds_read_b64_tr_b16 v[208:209], v48 offset:20480
  ds_read_b64_tr_b16 v[210:211], v48 offset:21504
  ds_read_b64_tr_b16 v[212:213], v49 offset:20480
  ds_read_b64_tr_b16 v[214:215], v49 offset:21504
  ds_read_b64_tr_b16 v[216:217], v50 offset:20480
  ds_read_b64_tr_b16 v[218:219], v50 offset:21504
  ds_read_b64_tr_b16 v[220:221], v51 offset:20480
  ds_read_b64_tr_b16 v[222:223], v51 offset:21504
  ds_read_b64_tr_b16 v[224:225], v48 offset:24576
  ds_read_b64_tr_b16 v[226:227], v48 offset:25600
  ds_read_b64_tr_b16 v[228:229], v49 offset:24576
  ds_read_b64_tr_b16 v[230:231], v49 offset:25600
  ds_read_b64_tr_b16 v[232:233], v50 offset:24576
  ds_read_b64_tr_b16 v[234:235], v50 offset:25600
  ds_read_b64_tr_b16 v[236:237], v51 offset:24576
  ds_read_b64_tr_b16 v[238:239], v51 offset:25600
  ds_read_b64_tr_b16 v[96:97], v48 offset:28672
  ds_read_b64_tr_b16 v[98:99], v48 offset:29696
  ds_read_b64_tr_b16 v[100:101], v49 offset:28672
  ds_read_b64_tr_b16 v[102:103], v49 offset:29696
  ds_read_b64_tr_b16 v[104:105], v50 offset:28672
  ds_read_b64_tr_b16 v[106:107], v50 offset:29696
  ds_read_b64_tr_b16 v[108:109], v51 offset:28672
  ds_read_b64_tr_b16 v[110:111], v51 offset:29696
  s_mov_b32 s92, 0
Larr_86:
  s_cmp_eq_u32 s37, 15
  s_cbranch_scc1 Larrd_87
  s_add_u32 s92, s92, 1
  s_cmp_ge_u32 s92, 320000
  s_cbranch_scc1 Larrd_87
  ds_read_b32 v9, v8
  s_waitcnt lgkmcnt(0)
  v_readfirstlane_b32 s36, v9
  s_nop 0
  s_lshr_b32 s85, s36, s46
  s_bitcmp1_b32 s37, 0
  s_cbranch_scc1 Lgl_88
  s_andn2_b32 s84, 0x00000303, s85
  s_cbranch_scc1 Lgl_88
  s_bitset1_b32 s37, 0
  s_mov_b32 s38, 0
  s_add_u32 s84, s41, 0
  buffer_load_dwordx4 v[16:19], v5, s[76:79], s84 offen sc1
  s_add_u32 s84, s41, 4096
  buffer_load_dwordx4 v[32:35], v5, s[76:79], s84 offen sc1
Lgl_88:
  s_bitcmp1_b32 s37, 1
  s_cbranch_scc1 Lgl_89
  s_andn2_b32 s84, 0x00000c0c, s85
  s_cbranch_scc1 Lgl_89
  s_bitset1_b32 s37, 1
  s_mov_b32 s38, 1
  s_add_u32 s84, s41, 1024
  buffer_load_dwordx4 v[20:23], v5, s[76:79], s84 offen sc1
  s_add_u32 s84, s41, 5120
  buffer_load_dwordx4 v[36:39], v5, s[76:79], s84 offen sc1
Lgl_89:
  s_bitcmp1_b32 s37, 2
  s_cbranch_scc1 Lgl_90
  s_andn2_b32 s84, 0x00003030, s85
  s_cbranch_scc1 Lgl_90
  s_bitset1_b32 s37, 2
  s_mov_b32 s38, 2
  s_add_u32 s84, s41, 2048
  buffer_load_dwordx4 v[24:27], v5, s[76:79], s84 offen sc1
  s_add_u32 s84, s41, 6144
  buffer_load_dwordx4 v[40:43], v5, s[76:79], s84 offen sc1
Lgl_90:
  s_bitcmp1_b32 s37, 3
  s_cbranch_scc1 Lgl_91
  s_andn2_b32 s84, 0x0000c0c0, s85
  s_cbranch_scc1 Lgl_91
  s_bitset1_b32 s37, 3
  s_mov_b32 s38, 3
  s_add_u32 s84, s41, 3072
  buffer_load_dwordx4 v[28:31], v5, s[76:79], s84 offen sc1
  s_add_u32 s84, s41, 7168
  buffer_load_dwordx4 v[44:47], v5, s[76:79], s84 offen sc1
Lgl_91:
  s_branch Larr_86
Larrd_87:
  s_waitcnt vmcnt(2) lgkmcnt(0)
  s_cmp_eq_u32 s38, 0
  s_cbranch_scc1 Lgm_92
  v_mfma_f32_16x16x32_bf16 v[64:67], v[128:131], v[16:19], v[64:67]
  v_mfma_f32_16x16x32_bf16 v[68:71], v[132:135], v[16:19], v[68:71]
  v_mfma_f32_16x16x32_bf16 v[72:75], v[136:139], v[16:19], v[72:75]
  v_mfma_f32_16x16x32_bf16 v[76:79], v[140:143], v[16:19], v[76:79]
  v_mfma_f32_16x16x32_bf16 v[64:67], v[192:195], v[32:35], v[64:67]
  v_mfma_f32_16x16x32_bf16 v[68:71], v[196:199], v[32:35], v[68:71]
  v_mfma_f32_16x16x32_bf16 v[72:75], v[200:203], v[32:35], v[72:75]
  v_mfma_f32_16x16x32_bf16 v[76:79], v[204:207], v[32:35], v[76:79]
Lgm_92:
  s_cmp_eq_u32 s38, 1
  s_cbranch_scc1 Lgm_93
  v_mfma_f32_16x16x32_bf16 v[64:67], v[144:147], v[20:23], v[64:67]
  v_mfma_f32_16x16x32_bf16 v[68:71], v[148:151], v[20:23], v[68:71]
  v_mfma_f32_16x16x32_bf16 v[72:75], v[152:155], v[20:23], v[72:75]
  v_mfma_f32_16x16x32_bf16 v[76:79], v[156:159], v[20:23], v[76:79]
  v_mfma_f32_16x16x32_bf16 v[64:67], v[208:211], v[36:39], v[64:67]
  v_mfma_f32_16x16x32_bf16 v[68:71], v[212:215], v[36:39], v[68:71]
  v_mfma_f32_16x16x32_bf16 v[72:75], v[216:219], v[36:39], v[72:75]
  v_mfma_f32_16x16x32_bf16 v[76:79], v[220:223], v[36:39], v[76:79]
Lgm_93:
  s_cmp_eq_u32 s38, 2
  s_cbranch_scc1 Lgm_94
  v_mfma_f32_16x16x32_bf16 v[64:67], v[160:163], v[24:27], v[64:67]
  v_mfma_f32_16x16x32_bf16 v[68:71], v[164:167], v[24:27], v[68:71]
  v_mfma_f32_16x16x32_bf16 v[72:75], v[168:171], v[24:27], v[72:75]
  v_mfma_f32_16x16x32_bf16 v[76:79], v[172:175], v[24:27], v[76:79]
  v_mfma_f32_16x16x32_bf16 v[64:67], v[224:227], v[40:43], v[64:67]
  v_mfma_f32_16x16x32_bf16 v[68:71], v[228:231], v[40:43], v[68:71]
  v_mfma_f32_16x16x32_bf16 v[72:75], v[232:235], v[40:43], v[72:75]
  v_mfma_f32_16x16x32_bf16 v[76:79], v[236:239], v[40:43], v[76:79]
Lgm_94:
  s_cmp_eq_u32 s38, 3
  s_cbranch_scc1 Lgm_95
  v_mfma_f32_16x16x32_bf16 v[64:67], v[176:179], v[28:31], v[64:67]
  v_mfma_f32_16x16x32_bf16 v[68:71], v[180:183], v[28:31], v[68:71]
  v_mfma_f32_16x16x32_bf16 v[72:75], v[184:187], v[28:31], v[72:75]
  v_mfma_f32_16x16x32_bf16 v[76:79], v[188:191], v[28:31], v[76:79]
  v_mfma_f32_16x16x32_bf16 v[64:67], v[96:99], v[44:47], v[64:67]
  v_mfma_f32_16x16x32_bf16 v[68:71], v[100:103], v[44:47], v[68:71]
  v_mfma_f32_16x16x32_bf16 v[72:75], v[104:107], v[44:47], v[72:75]
  v_mfma_f32_16x16x32_bf16 v[76:79], v[108:111], v[44:47], v[76:79]
Lgm_95:
  s_waitcnt vmcnt(0)
  s_cmp_lg_u32 s38, 0
  s_cbranch_scc1 Lgm_96
  v_mfma_f32_16x16x32_bf16 v[64:67], v[128:131], v[16:19], v[64:67]
  v_mfma_f32_16x16x32_bf16 v[68:71], v[132:135], v[16:19], v[68:71]
  v_mfma_f32_16x16x32_bf16 v[72:75], v[136:139], v[16:19], v[72:75]
  v_mfma_f32_16x16x32_bf16 v[76:79], v[140:143], v[16:19], v[76:79]
  v_mfma_f32_16x16x32_bf16 v[64:67], v[192:195], v[32:35], v[64:67]
  v_mfma_f32_16x16x32_bf16 v[68:71], v[196:199], v[32:35], v[68:71]
  v_mfma_f32_16x16x32_bf16 v[72:75], v[200:203], v[32:35], v[72:75]
  v_mfma_f32_16x16x32_bf16 v[76:79], v[204:207], v[32:35], v[76:79]
Lgm_96:
  s_cmp_lg_u32 s38, 1
  s_cbranch_scc1 Lgm_97
  v_mfma_f32_16x16x32_bf16 v[64:67], v[144:147], v[20:23], v[64:67]
  v_mfma_f32_16x16x32_bf16 v[68:71], v[148:151], v[20:23], v[68:71]
  v_mfma_f32_16x16x32_bf16 v[72:75], v[152:155], v[20:23], v[72:75]
  v_mfma_f32_16x16x32_bf16 v[76:79], v[156:159], v[20:23], v[76:79]
  v_mfma_f32_16x16x32_bf16 v[64:67], v[208:211], v[36:39], v[64:67]
  v_mfma_f32_16x16x32_bf16 v[68:71], v[212:215], v[36:39], v[68:71]
  v_mfma_f32_16x16x32_bf16 v[72:75], v[216:219], v[36:39], v[72:75]
  v_mfma_f32_16x16x32_bf16 v[76:79], v[220:223], v[36:39], v[76:79]
Lgm_97:
  s_cmp_lg_u32 s38, 2
  s_cbranch_scc1 Lgm_98
  v_mfma_f32_16x16x32_bf16 v[64:67], v[160:163], v[24:27], v[64:67]
  v_mfma_f32_16x16x32_bf16 v[68:71], v[164:167], v[24:27], v[68:71]
  v_mfma_f32_16x16x32_bf16 v[72:75], v[168:171], v[24:27], v[72:75]
  v_mfma_f32_16x16x32_bf16 v[76:79], v[172:175], v[24:27], v[76:79]
  v_mfma_f32_16x16x32_bf16 v[64:67], v[224:227], v[40:43], v[64:67]
  v_mfma_f32_16x16x32_bf16 v[68:71], v[228:231], v[40:43], v[68:71]
  v_mfma_f32_16x16x32_bf16 v[72:75], v[232:235], v[40:43], v[72:75]
  v_mfma_f32_16x16x32_bf16 v[76:79], v[236:239], v[40:43], v[76:79]
Lgm_98:
  s_cmp_lg_u32 s38, 3
  s_cbranch_scc1 Lgm_99
  v_mfma_f32_16x16x32_bf16 v[64:67], v[176:179], v[28:31], v[64:67]
  v_mfma_f32_16x16x32_bf16 v[68:71], v[180:183], v[28:31], v[68:71]
  v_mfma_f32_16x16x32_bf16 v[72:75], v[184:187], v[28:31], v[72:75]
  v_mfma_f32_16x16x32_bf16 v[76:79], v[188:191], v[28:31], v[76:79]
  v_mfma_f32_16x16x32_bf16 v[64:67], v[96:99], v[44:47], v[64:67]
  v_mfma_f32_16x16x32_bf16 v[68:71], v[100:103], v[44:47], v[68:71]
  v_mfma_f32_16x16x32_bf16 v[72:75], v[104:107], v[44:47], v[72:75]
  v_mfma_f32_16x16x32_bf16 v[76:79], v[108:111], v[44:47], v[76:79]
Lgm_99:
  s_branch Ljoin_80
Lpol_79:
  s_mov_b32 exec_lo, 0xffffffff
  s_mov_b32 exec_hi, 0x00000000
  buffer_load_dword v4, v6, s[76:79], s42 offen sc1
  s_mov_b64 exec, -1
  v_mov_b32 v2, 160844
  s_mov_b32 s92, 0
Lwo_100:
  ds_read_b32 v3, v2
  s_waitcnt lgkmcnt(0)
  v_readfirstlane_b32 s84, v3
  s_add_u32 s92, s92, 1
  s_cmp_ge_u32 s92, 40000
  s_cselect_b32 s84, 8, s84
  s_cmp_lt_u32 s84, 8
  s_cbranch_scc1 Lwo_100
  v_and_b32 v2, 7, v1
  v_lshlrev_b32 v2, 3, v2
  v_add_u32 v2, 162304, v2
  ds_read_b64 v[2:3], v2
  ds_read_b128 v[80:83], v7 offset:0
  ds_read_b128 v[88:91], v7 offset:1024
  ds_read_b128 v[84:87], v7 offset:64
  ds_read_b128 v[92:95], v7 offset:1088
  s_waitcnt lgkmcnt(4)
  v_add_f32_dpp v2, v2, v2 row_shr:1 row_mask:0xf bank_mask:0xf
  v_add_f32_dpp v3, v3, v3 row_shr:1 row_mask:0xf bank_mask:0xf
  s_nop 0
  v_add_f32_dpp v2, v2, v2 row_shr:2 row_mask:0xf bank_mask:0xf
  v_add_f32_dpp v3, v3, v3 row_shr:2 row_mask:0xf bank_mask:0xf
  s_nop 0
  v_add_f32_dpp v2, v2, v2 row_shr:4 row_mask:0xf bank_mask:0xf
  v_add_f32_dpp v3, v3, v3 row_shr:4 row_mask:0xf bank_mask:0xf
  v_readlane_b32 s39, v2, 7
  v_readlane_b32 s40, v3, 7
  ds_read_b64_tr_b16 v[128:129], v48 offset:0
  ds_read_b64_tr_b16 v[130:131], v48 offset:1024
  ds_read_b64_tr_b16 v[132:133], v49 offset:0
  ds_read_b64_tr_b16 v[134:135], v49 offset:1024
  ds_read_b64_tr_b16 v[136:137], v50 offset:0
  ds_read_b64_tr_b16 v[138:139], v50 offset:1024
  ds_read_b64_tr_b16 v[140:141], v51 offset:0
  ds_read_b64_tr_b16 v[142:143], v51 offset:1024
  ds_read_b64_tr_b16 v[144:145], v48 offset:4096
  ds_read_b64_tr_b16 v[146:147], v48 offset:5120
  ds_read_b64_tr_b16 v[148:149], v49 offset:4096
  ds_read_b64_tr_b16 v[150:151], v49 offset:5120
  ds_read_b64_tr_b16 v[152:153], v50 offset:4096
  ds_read_b64_tr_b16 v[154:155], v50 offset:5120
  ds_read_b64_tr_b16 v[156:157], v51 offset:4096
  ds_read_b64_tr_b16 v[158:159], v51 offset:5120
  ds_read_b64_tr_b16 v[160:161], v48 offset:8192
  ds_read_b64_tr_b16 v[162:163], v48 offset:9216
  ds_read_b64_tr_b16 v[164:165], v49 offset:8192
  ds_read_b64_tr_b16 v[166:167], v49 offset:9216
  ds_read_b64_tr_b16 v[168:169], v50 offset:8192
  ds_read_b64_tr_b16 v[170:171], v50 offset:9216
  ds_read_b64_tr_b16 v[172:173], v51 offset:8192
  ds_read_b64_tr_b16 v[174:175], v51 offset:9216
  ds_read_b64_tr_b16 v[176:177], v48 offset:12288
  ds_read_b64_tr_b16 v[178:179], v48 offset:13312
  ds_read_b64_tr_b16 v[180:181], v49 offset:12288
  ds_read_b64_tr_b16 v[182:183], v49 offset:13312
  ds_read_b64_tr_b16 v[184:185], v50 offset:12288
  ds_read_b64_tr_b16 v[186:187], v50 offset:13312
  ds_read_b64_tr_b16 v[188:189], v51 offset:12288
  ds_read_b64_tr_b16 v[190:191], v51 offset:13312
  ds_read_b64_tr_b16 v[192:193], v48 offset:16384
  ds_read_b64_tr_b16 v[194:195], v48 offset:17408
  ds_read_b64_tr_b16 v[196:197], v49 offset:16384
  ds_read_b64_tr_b16 v[198:199], v49 offset:17408
  ds_read_b64_tr_b16 v[200:201], v50 offset:16384
  ds_read_b64_tr_b16 v[202:203], v50 offset:17408
  ds_read_b64_tr_b16 v[204:205], v51 offset:16384
  ds_read_b64_tr_b16 v[206:207], v51 offset:17408
  ds_read_b64_tr_b16 v[208:209], v48 offset:20480
  ds_read_b64_tr_b16 v[210:211], v48 offset:21504
  ds_read_b64_tr_b16 v[212:213], v49 offset:20480
  ds_read_b64_tr_b16 v[214:215], v49 offset:21504
  ds_read_b64_tr_b16 v[216:217], v50 offset:20480
  ds_read_b64_tr_b16 v[218:219], v50 offset:21504
  ds_read_b64_tr_b16 v[220:221], v51 offset:20480
  ds_read_b64_tr_b16 v[222:223], v51 offset:21504
  ds_read_b64_tr_b16 v[224:225], v48 offset:24576
  ds_read_b64_tr_b16 v[226:227], v48 offset:25600
  ds_read_b64_tr_b16 v[228:229], v49 offset:24576
  ds_read_b64_tr_b16 v[230:231], v49 offset:25600
  ds_read_b64_tr_b16 v[232:233], v50 offset:24576
  ds_read_b64_tr_b16 v[234:235], v50 offset:25600
  ds_read_b64_tr_b16 v[236:237], v51 offset:24576
  ds_read_b64_tr_b16 v[238:239], v51 offset:25600
  ds_read_b64_tr_b16 v[96:97], v48 offset:28672
  ds_read_b64_tr_b16 v[98:99], v48 offset:29696
  ds_read_b64_tr_b16 v[100:101], v49 offset:28672
  ds_read_b64_tr_b16 v[102:103], v49 offset:29696
  ds_read_b64_tr_b16 v[104:105], v50 offset:28672
  ds_read_b64_tr_b16 v[106:107], v50 offset:29696
  ds_read_b64_tr_b16 v[108:109], v51 offset:28672
  ds_read_b64_tr_b16 v[110:111], v51 offset:29696
  s_mov_b32 s92, 0
Lpp_101:
  s_waitcnt vmcnt(0)
  v_cmp_eq_u32 vcc, s83, v4
  s_nop 0
  s_or_b32 s84, s36, vcc_lo
  s_cmp_eq_u32 s84, s36
  s_cbranch_scc1 Lpps_103
  s_mov_b32 s36, s84
  s_mov_b32 exec_lo, 0x00000001
  s_mov_b32 exec_hi, 0x00000000
  v_mov_b32 v9, s84
  ds_write_b32 v8, v9
  s_mov_b64 exec, -1
Lpps_103:
  s_cmp_eq_u32 s36, -1
  s_cbranch_scc1 Lppd_102
  s_add_u32 s92, s92, 1
  s_cmp_ge_u32 s92, 40000
  s_cbranch_scc1 Lppd_102
  s_mov_b32 exec_lo, 0xffffffff
  s_mov_b32 exec_hi, 0x00000000
  buffer_load_dword v4, v6, s[76:79], s42 offen sc1
  s_mov_b64 exec, -1
  s_branch Lpp_101
Lppd_102:
  s_add_u32 s84, s41, 0
  buffer_load_dwordx4 v[16:19], v5, s[76:79], s84 offen sc1
  s_add_u32 s84, s41, 1024
  buffer_load_dwordx4 v[20:23], v5, s[76:79], s84 offen sc1
  s_add_u32 s84, s41, 2048
  buffer_load_dwordx4 v[24:27], v5, s[76:79], s84 offen sc1
  s_add_u32 s84, s41, 3072
  buffer_load_dwordx4 v[28:31], v5, s[76:79], s84 offen sc1
  s_add_u32 s84, s41, 4096
  buffer_load_dwordx4 v[32:35], v5, s[76:79], s84 offen sc1
  s_add_u32 s84, s41, 5120
  buffer_load_dwordx4 v[36:39], v5, s[76:79], s84 offen sc1
  s_add_u32 s84, s41, 6144
  buffer_load_dwordx4 v[40:43], v5, s[76:79], s84 offen sc1
  s_add_u32 s84, s41, 7168
  buffer_load_dwordx4 v[44:47], v5, s[76:79], s84 offen sc1
  s_waitcnt lgkmcnt(0)
  s_waitcnt vmcnt(7)
  v_mfma_f32_16x16x32_bf16 v[64:67], v[128:131], v[16:19], v[64:67]
  v_mfma_f32_16x16x32_bf16 v[68:71], v[132:135], v[16:19], v[68:71]
  v_mfma_f32_16x16x32_bf16 v[72:75], v[136:139], v[16:19], v[72:75]
  v_mfma_f32_16x16x32_bf16 v[76:79], v[140:143], v[16:19], v[76:79]
  s_waitcnt vmcnt(6)
  v_mfma_f32_16x16x32_bf16 v[64:67], v[144:147], v[20:23], v[64:67]
  v_mfma_f32_16x16x32_bf16 v[68:71], v[148:151], v[20:23], v[68:71]
  v_mfma_f32_16x16x32_bf16 v[72:75], v[152:155], v[20:23], v[72:75]
  v_mfma_f32_16x16x32_bf16 v[76:79], v[156:159], v[20:23], v[76:79]
  s_waitcnt vmcnt(5)
  v_mfma_f32_16x16x32_bf16 v[64:67], v[160:163], v[24:27], v[64:67]
  v_mfma_f32_16x16x32_bf16 v[68:71], v[164:167], v[24:27], v[68:71]
  v_mfma_f32_16x16x32_bf16 v[72:75], v[168:171], v[24:27], v[72:75]
  v_mfma_f32_16x16x32_bf16 v[76:79], v[172:175], v[24:27], v[76:79]
  s_waitcnt vmcnt(4)
  v_mfma_f32_16x16x32_bf16 v[64:67], v[176:179], v[28:31], v[64:67]
  v_mfma_f32_16x16x32_bf16 v[68:71], v[180:183], v[28:31], v[68:71]
  v_mfma_f32_16x16x32_bf16 v[72:75], v[184:187], v[28:31], v[72:75]
  v_mfma_f32_16x16x32_bf16 v[76:79], v[188:191], v[28:31], v[76:79]
  s_waitcnt vmcnt(3)
  v_mfma_f32_16x16x32_bf16 v[64:67], v[192:195], v[32:35], v[64:67]
  v_mfma_f32_16x16x32_bf16 v[68:71], v[196:199], v[32:35], v[68:71]
  v_mfma_f32_16x16x32_bf16 v[72:75], v[200:203], v[32:35], v[72:75]
  v_mfma_f32_16x16x32_bf16 v[76:79], v[204:207], v[32:35], v[76:79]
  s_waitcnt vmcnt(2)
  v_mfma_f32_16x16x32_bf16 v[64:67], v[208:211], v[36:39], v[64:67]
  v_mfma_f32_16x16x32_bf16 v[68:71], v[212:215], v[36:39], v[68:71]
  v_mfma_f32_16x16x32_bf16 v[72:75], v[216:219], v[36:39], v[72:75]
  v_mfma_f32_16x16x32_bf16 v[76:79], v[220:223], v[36:39], v[76:79]
  s_waitcnt vmcnt(1)
  v_mfma_f32_16x16x32_bf16 v[64:67], v[224:227], v[40:43], v[64:67]
  v_mfma_f32_16x16x32_bf16 v[68:71], v[228:231], v[40:43], v[68:71]
  v_mfma_f32_16x16x32_bf16 v[72:75], v[232:235], v[40:43], v[72:75]
  v_mfma_f32_16x16x32_bf16 v[76:79], v[236:239], v[40:43], v[76:79]
  s_waitcnt vmcnt(0)
  v_mfma_f32_16x16x32_bf16 v[64:67], v[96:99], v[44:47], v[64:67]
  v_mfma_f32_16x16x32_bf16 v[68:71], v[100:103], v[44:47], v[68:71]
  v_mfma_f32_16x16x32_bf16 v[72:75], v[104:107], v[44:47], v[72:75]
  v_mfma_f32_16x16x32_bf16 v[76:79], v[108:111], v[44:47], v[76:79]
Ljoin_80:
  v_and_b32 v2, 7, v1
  v_lshrrev_b32 v3, 4, v1
  v_lshl_add_u32 v2, v3, 3, v2
  v_lshlrev_b32 v2, 4, v2
  s_lshl_b32 s84, s91, 12
  s_add_u32 s84, s84, 131072
  s_lshl_b32 s85, s96, 11
  s_xor_b32 s86, s85, 2048
  s_add_u32 s86, s86, s84
  s_add_u32 s85, s85, s84
  v_add_u32 v3, s86, v2
  v_bfe_u32 v4, v1, 3, 1
  v_lshl_add_u32 v2, v4, 10, v2
  v_add_u32 v2, s85, v2
  s_mov_b32 s84, 0xff00ff00
  s_cmp_eq_u32 s96, 0
  s_cselect_b32 s84, s84, 0x00ff00ff
  s_mov_b32 exec_lo, s84
  s_mov_b32 exec_hi, s84
  ds_write_b128 v3, v[64:67] offset:0
  ds_write_b128 v3, v[68:71] offset:512
  ds_write_b128 v3, v[72:75] offset:1024
  ds_write_b128 v3, v[76:79] offset:1536
  s_mov_b64 exec, -1
  ds_read_b128 v[16:19], v7 offset:256
  ds_read_b128 v[24:27], v7 offset:512
  ds_read_b128 v[32:35], v7 offset:768
  ds_read_b128 v[20:23], v7 offset:320
  ds_read_b128 v[28:31], v7 offset:576
  ds_read_b128 v[36:39], v7 offset:832
  s_waitcnt lgkmcnt(6)
  s_cmp_eq_u32 s96, 0
  s_cbranch_scc0 Lk_104
  v_mov_b32_dpp v64, v72 row_shr:8 row_mask:0xf bank_mask:0xc
  v_mov_b32_dpp v65, v73 row_shr:8 row_mask:0xf bank_mask:0xc
  v_mov_b32_dpp v66, v74 row_shr:8 row_mask:0xf bank_mask:0xc
  v_mov_b32_dpp v67, v75 row_shr:8 row_mask:0xf bank_mask:0xc
  v_mov_b32_dpp v68, v76 row_shr:8 row_mask:0xf bank_mask:0xc
  v_mov_b32_dpp v69, v77 row_shr:8 row_mask:0xf bank_mask:0xc
  v_mov_b32_dpp v70, v78 row_shr:8 row_mask:0xf bank_mask:0xc
  v_mov_b32_dpp v71, v79 row_shr:8 row_mask:0xf bank_mask:0xc
  s_branch Lk_105
Lk_104:
  v_mov_b32_dpp v64, v64 row_shl:8 row_mask:0xf bank_mask:0x3
  v_mov_b32_dpp v65, v65 row_shl:8 row_mask:0xf bank_mask:0x3
  v_mov_b32_dpp v66, v66 row_shl:8 row_mask:0xf bank_mask:0x3
  v_mov_b32_dpp v67, v67 row_shl:8 row_mask:0xf bank_mask:0x3
  v_mov_b32_dpp v68, v68 row_shl:8 row_mask:0xf bank_mask:0x3
  v_mov_b32_dpp v69, v69 row_shl:8 row_mask:0xf bank_mask:0x3
  v_mov_b32_dpp v70, v70 row_shl:8 row_mask:0xf bank_mask:0x3
  v_mov_b32_dpp v71, v71 row_shl:8 row_mask:0xf bank_mask:0x3
  v_mov_b32_dpp v64, v72 quad_perm:[0,1,2,3] row_mask:0xf bank_mask:0xc
  v_mov_b32_dpp v65, v73 quad_perm:[0,1,2,3] row_mask:0xf bank_mask:0xc
  v_mov_b32_dpp v66, v74 quad_perm:[0,1,2,3] row_mask:0xf bank_mask:0xc
  v_mov_b32_dpp v67, v75 quad_perm:[0,1,2,3] row_mask:0xf bank_mask:0xc
  v_mov_b32_dpp v68, v76 quad_perm:[0,1,2,3] row_mask:0xf bank_mask:0xc
  v_mov_b32_dpp v69, v77 quad_perm:[0,1,2,3] row_mask:0xf bank_mask:0xc
  v_mov_b32_dpp v70, v78 quad_perm:[0,1,2,3] row_mask:0xf bank_mask:0xc
  v_mov_b32_dpp v71, v79 quad_perm:[0,1,2,3] row_mask:0xf bank_mask:0xc
Lk_105:
  v_permlane16_swap_b32 v116, v118
  v_permlane16_swap_b32 v117, v119
  v_lshlrev_b32 v40, 16, v116
  v_and_b32 v41, 0xffff0000, v116
  v_lshlrev_b32 v42, 16, v117
  v_and_b32 v43, 0xffff0000, v117
  v_lshlrev_b32 v44, 16, v118
  v_and_b32 v45, 0xffff0000, v118
  v_lshlrev_b32 v46, 16, v119
  v_and_b32 v47, 0xffff0000, v119
  s_barrier
  ds_read_b128 v[52:55], v2 offset:0
  ds_read_b128 v[56:59], v2 offset:512
  s_waitcnt lgkmcnt(0)
  v_add_f32 v64, v64, v52
  v_add_f32 v65, v65, v53
  v_add_f32 v66, v66, v54
  v_add_f32 v67, v67, v55
  v_add_f32 v68, v68, v56
  v_add_f32 v69, v69, v57
  v_add_f32 v70, v70, v58
  v_add_f32 v71, v71, v59
  v_fmac_f32 v40, v80, v64
  v_fmac_f32 v41, v81, v65
  v_fmac_f32 v42, v82, v66
  v_fmac_f32 v43, v83, v67
  v_fmac_f32 v44, v84, v68
  v_fmac_f32 v45, v85, v69
  v_fmac_f32 v46, v86, v70
  v_fmac_f32 v47, v87, v71
  v_add_f32 v68, v40, v41
  v_mul_f32 v69, v40, v40
  v_mul_f32 v70, v40, v88
  v_fmac_f32 v69, v41, v41
  v_fmac_f32 v70, v41, v89
  v_add_f32 v68, v68, v42
  v_fmac_f32 v69, v42, v42
  v_fmac_f32 v70, v42, v90
  v_add_f32 v68, v68, v43
  v_fmac_f32 v69, v43, v43
  v_fmac_f32 v70, v43, v91
  v_add_f32 v68, v68, v44
  v_fmac_f32 v69, v44, v44
  v_fmac_f32 v70, v44, v92
  v_add_f32 v68, v68, v45
  v_fmac_f32 v69, v45, v45
  v_fmac_f32 v70, v45, v93
  v_add_f32 v68, v68, v46
  v_fmac_f32 v69, v46, v46
  v_fmac_f32 v70, v46, v94
  v_add_f32 v68, v68, v47
  v_fmac_f32 v69, v47, v47
  v_fmac_f32 v70, v47, v95
  v_mov_b32 v72, v70
  v_permlane32_swap_b32 v68, v69
  s_nop 0
  v_permlane32_swap_b32 v70, v72
  v_add_f32 v68, v68, v69
  v_add_f32 v70, v70, v72
  v_mov_b32 v72, v68
  v_mov_b32 v73, v70
  s_nop 0
  v_permlane16_swap_b32 v68, v72
  v_permlane16_swap_b32 v70, v73
  v_add_f32 v68, v68, v72
  v_add_f32 v70, v70, v73
  s_nop 0
  v_add_f32_dpp v68, v68, v68 row_ror:8 row_mask:0xf bank_mask:0xf
  v_add_f32_dpp v70, v70, v70 row_ror:8 row_mask:0xf bank_mask:0xf
  v_mov_b32 v71, s83
  v_permlane32_swap_b32 v68, v69
  s_lshl_b32 s85, s94, 10
  s_add_u32 s85, s85, 13631488
  s_lshl_b32 s84, s95, 7
  s_add_u32 s84, s84, s85
  s_mov_b32 exec_lo, 0x000000ff
  s_mov_b32 exec_hi, 0x00000000
  s_add_u32 s86, s84, 262144
  buffer_store_dwordx4 v[68:71], v5, s[76:79], s86 offen
  buffer_store_dwordx4 v[68:71], v5, s[76:79], s84 offen sc1
  s_mov_b64 exec, -1
  s_add_u32 s86, s85, 262144
  s_mov_b32 s92, 0
  s_sleep 6
Lrq_107:
  buffer_load_dwordx4 v[68:71], v5, s[76:79], s86 offen sc1
  s_waitcnt vmcnt(0)
  v_cmp_ne_u32 vcc, s83, v71
  s_cbranch_vccz Lrs_106
  s_add_u32 s92, s92, 1
  s_cmp_lt_u32 s92, 6
  s_cbranch_scc1 Lrq_107
  buffer_load_dwordx4 v[68:71], v5, s[76:79], s85 offen sc1
  s_mov_b32 s92, 0
  s_waitcnt vmcnt(0)
  v_cmp_ne_u32 s[52:53], s83, v71
Lmp_108:
  s_nop 0
  s_cmp_eq_u64 s[52:53], 0
  s_cbranch_scc1 Lmpd_109
  s_add_u32 s92, s92, 1
  s_cmp_ge_u32 s92, 40000
  s_cbranch_scc1 Lmpd_109
  s_sleep 1
  s_mov_b64 exec, s[52:53]
  s_cbranch_execz Lmps_110
  buffer_load_dwordx4 v[68:71], v5, s[76:79], s85 offen sc1
Lmps_110:
  s_waitcnt vmcnt(0)
  s_mov_b64 exec, s[52:53]
  v_cmp_ne_u32 s[52:53], s83, v71
  s_mov_b64 exec, -1
  s_branch Lmp_108
Lmpd_109:
Lrs_106:
  v_add_f32_dpp v68, v68, v68 row_ror:8 row_mask:0xf bank_mask:0xf
  v_add_f32_dpp v69, v69, v69 row_ror:8 row_mask:0xf bank_mask:0xf
  v_add_f32_dpp v70, v70, v70 row_ror:8 row_mask:0xf bank_mask:0xf
  v_mov_b32 v72, v68
  v_mov_b32 v73, v69
  v_mov_b32 v74, v70
  v_permlane32_swap_b32 v68, v72
  v_permlane32_swap_b32 v69, v73
  v_permlane32_swap_b32 v70, v74
  v_add_f32 v68, v68, v72
  v_add_f32 v69, v69, v73
  v_add_f32 v70, v70, v74
  v_mov_b32 v72, v68
  v_mov_b32 v73, v69
  v_mov_b32 v74, v70
  v_permlane16_swap_b32 v68, v72
  v_permlane16_swap_b32 v69, v73
  v_permlane16_swap_b32 v70, v74
  v_add_f32 v68, v68, v72
  v_add_f32 v69, v69, v73
  v_add_f32 v70, v70, v74
  v_mul_f32 v84, 0x3b000000, v68
  v_mul_f32 v69, 0x3b000000, v69
  v_fma_f32 v69, -v84, v84, v69
  v_max_f32 v69, 0, v69
  v_add_f32 v69, 0x3727c5ac, v69
  v_rsq_f32 v85, v69
  v_mov_b32 v71, s40
  v_fma_f32 v86, -v84, s39, v70
  v_fma_f32 v86, v86, v85, v71
  v_mov_b32 v87, v86
  s_nop 1
  v_max_f32_dpp v87, v87, v87 row_shr:1 row_mask:0xf bank_mask:0xf
  s_nop 1
  v_max_f32_dpp v87, v87, v87 row_shr:2 row_mask:0xf bank_mask:0xf
  s_nop 1
  v_max_f32_dpp v87, v87, v87 row_shr:4 row_mask:0xf bank_mask:0xf
  s_nop 0
  v_readlane_b32 s10, v87, 7
  s_nop 1
  v_cmp_eq_f32 vcc, s10, v86
  s_nop 0
  s_ff1_i32_b64 s43, vcc
  s_and_b32 s43, s43, 7
  s_cmp_lg_u32 s95, 0
  s_cbranch_scc1 Lcand_111
  s_lshl_b32 s85, s94, 3
  s_add_u32 s85, s85, s43
  v_mov_b32 v8, s10
  v_mov_b32 v9, s85
  s_and_b32 s85, s94, 7
  s_lshl_b32 s85, s85, 3
  s_add_u32 s85, s85, 162432
  v_mov_b32 v10, s85
  s_mov_b32 exec_lo, 0x00000001
  s_mov_b32 exec_hi, 0x00000000
  ds_write_b64 v10, v[8:9]
  s_mov_b64 exec, -1
  v_mov_b32 v10, 160856
  v_mov_b32 v11, 1
  s_mov_b32 exec_lo, 0x00000001
  s_mov_b32 exec_hi, 0x00000000
  ds_add_rtn_u32 v11, v10, v11
  s_waitcnt lgkmcnt(0)
  s_mov_b64 exec, -1
  v_readfirstlane_b32 s84, v11
  s_nop 0
  s_cmp_lg_u32 s84, 7
  s_cbranch_scc1 Lcand_111
  v_and_b32 v10, 7, v1
  v_lshlrev_b32 v10, 3, v10
  v_add_u32 v10, 162432, v10
  ds_read_b64 v[8:9], v10
  s_waitcnt lgkmcnt(0)
  v_mov_b32 v10, v8
  s_nop 1
  v_max_f32_dpp v10, v10, v10 row_shr:1 row_mask:0xf bank_mask:0xf
  s_nop 1
  v_max_f32_dpp v10, v10, v10 row_shr:2 row_mask:0xf bank_mask:0xf
  s_nop 1
  v_max_f32_dpp v10, v10, v10 row_shr:4 row_mask:0xf bank_mask:0xf
  s_nop 0
  v_readlane_b32 s84, v10, 7
  s_nop 1
  v_cmp_eq_f32 vcc, s84, v8
  s_nop 0
  s_ff1_i32_b64 s85, vcc
  s_and_b32 s85, s85, 7
  v_readlane_b32 s85, v9, s85
  v_mov_b32 v2, 0
  v_mov_b32 v8, s84
  v_mov_b32 v9, s85
  v_mov_b32 v10, s83
  v_mov_b32 v11, 0
  s_lshl_b32 s84, s93, 7
  s_add_u32 s84, s84, 524288
  s_mov_b32 exec_lo, 0x00000001
  s_mov_b32 exec_hi, 0x00000000
  buffer_store_dwordx4 v[8:11], v2, s[76:79], s84 offen sc1
  s_mov_b64 exec, -1
Lcand_111:
  s_waitcnt lgkmcnt(0)
  v_sub_f32 v48, v40, v84
  v_sub_f32 v49, v41, v84
  v_sub_f32 v50, v42, v84
  v_sub_f32 v51, v43, v84
  v_sub_f32 v52, v44, v84
  v_sub_f32 v53, v45, v84
  v_sub_f32 v54, v46, v84
  v_sub_f32 v55, v47, v84
  v_mul_f32 v48, v48, v85
  v_mul_f32 v49, v49, v85
  v_mul_f32 v50, v50, v85
  v_mul_f32 v51, v51, v85
  v_mul_f32 v52, v52, v85
  v_mul_f32 v53, v53, v85
  v_mul_f32 v54, v54, v85
  v_mul_f32 v55, v55, v85
  v_fma_f32 v48, v48, v24, v16
  v_fma_f32 v49, v49, v25, v17
  v_fma_f32 v50, v50, v26, v18
  v_fma_f32 v51, v51, v27, v19
  v_fma_f32 v52, v52, v28, v20
  v_fma_f32 v53, v53, v29, v21
  v_fma_f32 v54, v54, v30, v22
  v_fma_f32 v55, v55, v31, v23
  v_fma_f32 v56, v32, v48, v40
  v_fma_f32 v57, v33, v49, v41
  v_fma_f32 v58, v34, v50, v42
  v_fma_f32 v59, v35, v51, v43
  v_fma_f32 v60, v36, v52, v44
  v_fma_f32 v61, v37, v53, v45
  v_fma_f32 v62, v38, v54, v46
  v_fma_f32 v63, v39, v55, v47
  v_cvt_pk_bf16_f32 v16, v48, v49
  v_mov_b32 v17, v56
  v_mov_b32 v18, v57
  v_mov_b32 v19, s83
  v_cvt_pk_bf16_f32 v20, v50, v51
  v_mov_b32 v21, v58
  v_mov_b32 v22, v59
  v_mov_b32 v23, s83
  v_cvt_pk_bf16_f32 v24, v52, v53
  v_mov_b32 v25, v60
  v_mov_b32 v26, v61
  v_mov_b32 v27, s83
  v_cvt_pk_bf16_f32 v28, v54, v55
  v_mov_b32 v29, v62
  v_mov_b32 v30, v63
  v_mov_b32 v31, s83
  s_lshl_b32 s84, s82, 9
  s_add_u32 s84, s84, 155648
  v_lshrrev_b32 v8, 4, v1
  v_lshl_add_u32 v9, v8, 5, s84
  v_bfe_u32 v8, v1, 3, 1
  v_lshl_add_u32 v9, v8, 8, v9
  v_lshl_add_u32 v8, v1, 4, s84
  s_lshl_b32 s86, 0x01010101, s43
  s_mov_b32 exec_lo, s86
  s_mov_b32 exec_hi, s86
  ds_write_b128 v9, v[16:19] offset:0
  ds_write_b128 v9, v[20:23] offset:16
  ds_write_b128 v9, v[24:27] offset:128
  ds_write_b128 v9, v[28:31] offset:144
  s_mov_b32 exec_lo, 0xffffffff
  s_mov_b32 exec_hi, 0x00000000
  s_waitcnt lgkmcnt(0)
  ds_read_b128 v[32:35], v8
  s_lshl_b32 s84, s95, 9
  s_lshl_b32 s85, s94, 12
  s_add_u32 s84, s84, s85
  s_add_u32 s84, s84, 14680064
  s_waitcnt lgkmcnt(0)
  buffer_store_dwordx4 v[32:35], v5, s[76:79], s84 offen sc1
  s_mov_b32 exec_lo, 0x0000000f
  s_mov_b32 exec_hi, 0x00000000
  v_lshlrev_b32 v9, 7, v1
  s_lshl_b32 s87, s82, 9
  s_add_u32 s87, s87, 524288
  s_mov_b64 exec, -1
  v_cvt_pk_bf16_f32 v64, v56, v57
  v_cvt_pk_bf16_f32 v65, v58, v59
  v_cvt_pk_bf16_f32 v66, v60, v61
  v_cvt_pk_bf16_f32 v67, v62, v63
  s_nop 0
  v_permlane16_swap_b32 v64, v66
  v_permlane16_swap_b32 v65, v67
  v_and_b32 v10, 7, v1
  v_lshlrev_b32 v12, 10, v10
  v_bfe_u32 v11, v1, 3, 1
  v_lshl_add_u32 v12, v11, 6, v12
  v_bfe_u32 v11, v1, 4, 1
  v_lshl_add_u32 v12, v11, 5, v12
  v_lshrrev_b32 v11, 5, v1
  v_lshl_add_u32 v12, v11, 4, v12
  s_lshl_b32 s41, s94, 13
  s_lshl_b32 s85, s95, 7
  s_add_u32 s41, s41, s85
  v_cmp_ne_u32 vcc, s43, v10
  s_nop 0
  s_and_saveexec_b64 s[8:9], vcc
  buffer_store_dwordx4 v[64:67], v12, s[72:75], s41 offen
  s_mov_b64 exec, s[8:9]
  v_lshlrev_b32 v128, 16, v120
  v_and_b32 v129, 0xffff0000, v120
  v_lshlrev_b32 v130, 16, v121
  v_and_b32 v131, 0xffff0000, v121
  v_lshlrev_b32 v132, 16, v122
  v_and_b32 v133, 0xffff0000, v122
  v_lshlrev_b32 v134, 16, v123
  v_and_b32 v135, 0xffff0000, v123
  v_lshlrev_b32 v136, 16, v124
  v_and_b32 v137, 0xffff0000, v124
  v_lshlrev_b32 v138, 16, v125
  v_and_b32 v139, 0xffff0000, v125
  v_lshlrev_b32 v140, 16, v126
  v_and_b32 v141, 0xffff0000, v126
  v_lshlrev_b32 v142, 16, v127
  v_and_b32 v143, 0xffff0000, v127
  v_lshlrev_b32 v144, 16, v240
  v_and_b32 v145, 0xffff0000, v240
  v_lshlrev_b32 v146, 16, v241
  v_and_b32 v147, 0xffff0000, v241
  v_lshlrev_b32 v148, 16, v242
  v_and_b32 v149, 0xffff0000, v242
  v_lshlrev_b32 v150, 16, v243
  v_and_b32 v151, 0xffff0000, v243
  v_lshlrev_b32 v152, 16, v244
  v_and_b32 v153, 0xffff0000, v244
  v_lshlrev_b32 v154, 16, v245
  v_and_b32 v155, 0xffff0000, v245
  v_lshlrev_b32 v156, 16, v246
  v_and_b32 v157, 0xffff0000, v246
  v_lshlrev_b32 v158, 16, v247
  v_and_b32 v159, 0xffff0000, v247
  v_lshlrev_b32 v160, 16, v248
  v_and_b32 v161, 0xffff0000, v248
  v_lshlrev_b32 v162, 16, v249
  v_and_b32 v163, 0xffff0000, v249
  v_lshlrev_b32 v164, 16, v250
  v_and_b32 v165, 0xffff0000, v250
  v_lshlrev_b32 v166, 16, v251
  v_and_b32 v167, 0xffff0000, v251
  v_lshlrev_b32 v168, 16, v252
  v_and_b32 v169, 0xffff0000, v252
  v_lshlrev_b32 v170, 16, v253
  v_and_b32 v171, 0xffff0000, v253
  v_lshlrev_b32 v172, 16, v254
  v_and_b32 v173, 0xffff0000, v254
  v_lshlrev_b32 v174, 16, v255
  v_and_b32 v175, 0xffff0000, v255
  v_lshrrev_b32 v176, 4, v1
  v_and_b32 v177, 1, v176
  v_lshlrev_b32 v177, 1, v177
  v_lshrrev_b32 v176, 1, v176
  v_or_b32 v177, v176, v177
  s_lshl_b32 s84, s82, 6
  s_add_u32 s84, s84, 160256
  v_lshl_add_u32 v176, v177, 2, s84
  s_lshl_b32 s84, s82, 5
  s_add_u32 s84, s84, 159744
  v_lshl_add_u32 v177, v177, 2, s84
  v_and_b32 v178, 15, v1
  v_lshlrev_b32 v178, 2, v178
  v_add_u32 v178, 160256, v178
  v_and_b32 v180, 7, v1
  v_lshlrev_b32 v179, 2, v180
  v_add_u32 v179, 159744, v179
  v_lshlrev_b32 v180, 1, v180
  v_lshlrev_b32 v181, 3, v1
  s_mov_b32 exec_lo, 0x0000000f
  s_mov_b32 exec_hi, 0x00000000
  s_sleep 14
  buffer_load_dwordx4 v[24:27], v9, s[76:79], s87 offen sc1
  s_waitcnt vmcnt(0)
  v_cmp_ne_u32 vcc, s83, v26
  s_cbranch_vccz Lcd_113
  s_mov_b32 s92, 0
Lcp_112:
  s_mov_b64 exec, vcc
  buffer_load_dwordx4 v[24:27], v9, s[76:79], s87 offen sc1
  s_waitcnt vmcnt(0)
  v_cmp_ne_u32 vcc, s83, v26
  s_cbranch_vccz Lcd_113
  s_add_u32 s92, s92, 1
  s_cmp_lt_u32 s92, 40000
  s_cbranch_scc1 Lcp_112
Lcd_113:
  s_mov_b32 exec_lo, 0x0000000f
  s_mov_b32 exec_hi, 0x00000000
  v_mov_b32 v28, v24
  s_nop 1
  v_max_f32_dpp v28, v28, v28 row_shr:1 row_mask:0xf bank_mask:0xf
  s_nop 1
  v_max_f32_dpp v28, v28, v28 row_shr:2 row_mask:0xf bank_mask:0xf
  s_nop 0
  v_readlane_b32 s84, v28, 3
  s_nop 1
  v_cmp_eq_f32 vcc, s84, v24
  s_nop 0
  s_ff1_i32_b64 s85, vcc
  s_and_b32 s85, s85, 3
  v_readlane_b32 s86, v25, s85
  v_mov_b32 v28, s84
  s_nop 0
  v_mov_b32 v29, s86
  s_lshl_b32 s85, s82, 3
  s_add_u32 s85, s85, 162368
  v_mov_b32 v30, s85
  s_mov_b32 exec_lo, 0x00000001
  s_mov_b32 exec_hi, 0x00000000
  ds_write_b64 v30, v[28:29]
  s_mov_b64 exec, -1
  v_and_b32 v30, 7, v1
  v_lshlrev_b32 v30, 3, v30
  v_add_u32 v30, 162368, v30
  s_waitcnt lgkmcnt(0)
  s_barrier
  ds_read_b64 v[28:29], v30
  s_waitcnt lgkmcnt(0)
  v_mov_b32 v30, v28
  s_nop 1
  v_max_f32_dpp v30, v30, v30 row_shr:1 row_mask:0xf bank_mask:0xf
  s_nop 1
  v_max_f32_dpp v30, v30, v30 row_shr:2 row_mask:0xf bank_mask:0xf
  s_nop 1
  v_max_f32_dpp v30, v30, v30 row_shr:4 row_mask:0xf bank_mask:0xf
  s_nop 0
  v_readlane_b32 s10, v30, 7
  s_nop 1
  v_cmp_eq_f32 vcc, s10, v28
  s_nop 0
  s_ff1_i32_b64 s84, vcc
  s_and_b32 s84, s84, 7
  v_readlane_b32 s97, v29, s84
  s_nop 0
  s_and_b32 s97, s97, 2047
  s_lshr_b32 s87, s97, 3
  s_lshl_b32 s87, s87, 12
  s_add_u32 s87, s87, 14680064
  v_lshrrev_b32 v10, 1, v0
  v_lshlrev_b32 v10, 4, v10
  s_cmp_ge_u32 s99, 28
  s_cbranch_scc1 Lgu0_115
  s_mov_b32 s92, 0
Lpoll_116:
  buffer_load_dwordx4 v[24:27], v10, s[76:79], s87 offen sc1
  s_waitcnt vmcnt(0)
  v_cmp_ne_u32 vcc, s83, v27
  s_cbranch_vccz Lpolld_117
  s_add_u32 s92, s92, 1
  s_cmp_lt_u32 s92, 40000
  s_cbranch_scc1 Lpoll_116
Lpolld_117:
Lgu0_115:
  s_cmp_lt_u32 s99, 24
  s_cbranch_scc1 Lnb_118
  s_lshl_b32 s11, s98, 3
  s_add_u32 s11, s11, s99
  s_sub_u32 s11, s11, 24
  v_and_b32 v15, 7, v1
  v_lshrrev_b32 v13, 1, v15
  v_lshlrev_b32 v13, 4, v13
  s_lshl_b32 s85, s11, 6
  s_add_u32 s36, s87, s85
  v_lshlrev_b32 v14, 3, v15
  s_add_u32 s37, s85, 24576
  buffer_load_dwordx4 v[40:43], v13, s[76:79], s36 offen sc1
  buffer_load_dwordx2 v[44:45], v14, s[76:79], s37 offen sc1
Lnb_118:
  s_lshl_b32 s84, s94, 3
  s_add_u32 s84, s84, s43
  s_cmp_eq_u32 s84, s97
  s_cbranch_scc1 Ldef_119
  v_and_b32 v11, 7, v1
  v_cmp_eq_u32 vcc, s43, v11
  s_nop 0
  s_and_saveexec_b64 s[8:9], vcc
  buffer_store_dwordx4 v[64:67], v12, s[72:75], s41 offen
  s_mov_b64 exec, s[8:9]
Ldef_119:
  s_cmp_ge_u32 s99, 28
  s_cbranch_scc1 Lngu_114
  s_mov_b32 vcc_lo, 0xaaaaaaaa
  s_mov_b32 vcc_hi, 0xaaaaaaaa
  v_lshlrev_b32 v2, 16, v24
  v_and_b32 v3, 0xffff0000, v24
  v_cndmask_b32 v2, v2, v3, vcc
  v_mul_f32 v16, v128, v2
  v_mul_f32 v17, v129, v2
  v_mul_f32 v18, v130, v2
  v_mul_f32 v19, v131, v2
  v_mul_f32 v20, v132, v2
  v_mul_f32 v21, v133, v2
  v_mul_f32 v22, v134, v2
  v_mul_f32 v23, v135, v2
  v_mul_f32 v24, v136, v2
  v_mul_f32 v25, v137, v2
  v_mul_f32 v26, v138, v2
  v_mul_f32 v27, v139, v2
  v_mul_f32 v28, v140, v2
  v_mul_f32 v29, v141, v2
  v_mul_f32 v30, v142, v2
  v_mul_f32 v31, v143, v2
  v_permlane32_swap_b32 v16, v17
  v_permlane32_swap_b32 v18, v19
  v_permlane32_swap_b32 v20, v21
  v_permlane32_swap_b32 v22, v23
  v_permlane32_swap_b32 v24, v25
  v_permlane32_swap_b32 v26, v27
  v_permlane32_swap_b32 v28, v29
  v_permlane32_swap_b32 v30, v31
  v_add_f32 v16, v16, v17
  v_add_f32 v18, v18, v19
  v_add_f32 v20, v20, v21
  v_add_f32 v22, v22, v23
  v_add_f32 v24, v24, v25
  v_add_f32 v26, v26, v27
  v_add_f32 v28, v28, v29
  v_add_f32 v30, v30, v31
  v_permlane16_swap_b32 v16, v18
  v_permlane16_swap_b32 v20, v22
  v_permlane16_swap_b32 v24, v26
  v_permlane16_swap_b32 v28, v30
  v_add_f32 v16, v16, v18
  v_add_f32 v20, v20, v22
  v_add_f32 v24, v24, v26
  v_add_f32 v28, v28, v30
  v_add_f32_dpp v16, v16, v16 row_shr:1 row_mask:0xf bank_mask:0xf
  v_add_f32_dpp v20, v20, v20 row_shr:1 row_mask:0xf bank_mask:0xf
  v_add_f32_dpp v24, v24, v24 row_shr:1 row_mask:0xf bank_mask:0xf
  v_add_f32_dpp v28, v28, v28 row_shr:1 row_mask:0xf bank_mask:0xf
  v_add_f32_dpp v16, v16, v16 row_shr:2 row_mask:0xf bank_mask:0xf
  v_add_f32_dpp v20, v20, v20 row_shr:2 row_mask:0xf bank_mask:0xf
  v_add_f32_dpp v24, v24, v24 row_shr:2 row_mask:0xf bank_mask:0xf
  v_add_f32_dpp v28, v28, v28 row_shr:2 row_mask:0xf bank_mask:0xf
  v_add_f32_dpp v16, v16, v16 row_shr:4 row_mask:0xf bank_mask:0xf
  v_add_f32_dpp v20, v20, v20 row_shr:4 row_mask:0xf bank_mask:0xf
  v_add_f32_dpp v24, v24, v24 row_shr:4 row_mask:0xf bank_mask:0xf
  v_add_f32_dpp v28, v28, v28 row_shr:4 row_mask:0xf bank_mask:0xf
  v_add_f32_dpp v16, v16, v16 row_shr:8 row_mask:0xf bank_mask:0xf
  v_add_f32_dpp v20, v20, v20 row_shr:8 row_mask:0xf bank_mask:0xf
  v_add_f32_dpp v24, v24, v24 row_shr:8 row_mask:0xf bank_mask:0xf
  v_add_f32_dpp v28, v28, v28 row_shr:8 row_mask:0xf bank_mask:0xf
  s_mov_b32 exec_lo, 0x80008000
  s_mov_b32 exec_hi, 0x80008000
  ds_write_b32 v176, v16 offset:0
  ds_write_b32 v176, v20 offset:16
  ds_write_b32 v176, v24 offset:32
  ds_write_b32 v176, v28 offset:48
  s_mov_b64 exec, -1
  s_waitcnt lgkmcnt(0)
  s_barrier
  s_cmp_lg_u32 s82, 0
  s_cbranch_scc1 Lact_120
  ds_read_b32 v16, v178 offset:0
  ds_read_b32 v17, v178 offset:64
  ds_read_b32 v18, v178 offset:128
  ds_read_b32 v19, v178 offset:192
  ds_read_b32 v20, v178 offset:256
  ds_read_b32 v21, v178 offset:320
  ds_read_b32 v22, v178 offset:384
  ds_read_b32 v23, v178 offset:448
  s_waitcnt lgkmcnt(0)
  v_add_f32 v16, v16, v17
  v_add_f32 v18, v18, v19
  v_add_f32 v20, v20, v21
  v_add_f32 v22, v22, v23
  v_add_f32 v16, v16, v18
  v_add_f32 v20, v20, v22
  v_add_f32 v16, v16, v20
  s_nop 1
  v_mov_b32_dpp v17, v16 row_shl:8 row_mask:0xf bank_mask:0xf
  v_mul_f32 v18, 0xbfb8aa3b, v16
  v_exp_f32 v18, v18
  s_nop 0
  v_add_f32 v18, 1.0, v18
  v_rcp_f32 v18, v18
  s_nop 0
  v_mul_f32 v18, v16, v18
  v_mul_f32 v18, v18, v17
  v_mov_b32 v19, s83
  s_mul_i32 s84, s98, 28
  s_add_u32 s84, s84, s99
  s_lshl_b32 s84, s84, 7
  s_add_u32 s84, s84, 540672
  s_mov_b32 exec_lo, 0x000000ff
  s_mov_b32 exec_hi, 0x00000000
  buffer_store_dwordx2 v[18:19], v181, s[76:79], s84 offen sc1
  s_mov_b64 exec, -1
Lact_120:
Lngu_114:
  s_cmp_lt_u32 s99, 24
  s_cbranch_scc1 Lnd_121
  v_lshrrev_b32 v10, 3, v0
  v_lshlrev_b32 v10, 7, v10
  v_and_b32 v11, 7, v0
  v_lshl_add_u32 v10, v11, 3, v10
  v_and_b32 v11, 0xfff, v10
  s_mov_b32 s84, 540672
  s_mov_b32 s85, 548864
  s_mov_b32 s86, 557056
  s_mov_b32 s87, 565248
  s_cmp_ge_u32 s99, 28
  s_cbranch_scc1 La_122
  s_sleep 16
  s_branch La_123
La_122:
  s_sleep 22
La_123:
  buffer_load_dwordx2 v[24:25], v10, s[76:79], s84 offen sc1
  buffer_load_dwordx2 v[26:27], v10, s[76:79], s85 offen sc1
  buffer_load_dwordx2 v[28:29], v10, s[76:79], s86 offen sc1
  buffer_load_dwordx2 v[30:31], v11, s[76:79], s87 offen sc1
  s_waitcnt vmcnt(4)
  v_cmp_ne_u32 s[8:9], s83, v43
  v_cmp_ne_u32 vcc, s83, v45
  s_nop 0
  s_or_b64 vcc, s[8:9], vcc
  s_cbranch_vccz Lbok_124
  v_and_b32 v15, 7, v1
  v_lshrrev_b32 v13, 1, v15
  v_lshlrev_b32 v13, 4, v13
  v_lshlrev_b32 v14, 3, v15
  s_mov_b32 s92, 0
Lpoll_125:
  buffer_load_dwordx4 v[40:43], v13, s[76:79], s36 offen sc1
  buffer_load_dwordx2 v[44:45], v14, s[76:79], s37 offen sc1
  s_waitcnt vmcnt(0)
  v_cmp_ne_u32 s[8:9], s83, v43
  v_cmp_ne_u32 vcc, s83, v45
  s_nop 0
  s_or_b64 vcc, s[8:9], vcc
  s_cbranch_vccz Lpolld_126
  s_sleep 1
  s_add_u32 s92, s92, 1
  s_cmp_lt_u32 s92, 40000
  s_cbranch_scc1 Lpoll_125
Lpolld_126:
Lbok_124:
  v_and_b32 v15, 1, v1
  v_cmp_eq_u32 vcc, 1, v15
  s_nop 1
  v_cndmask_b32 v46, v41, v42, vcc
  v_mov_b32 v47, s10
  v_mul_f32 v47, 0xbfb8aa3b, v47
  v_exp_f32 v47, v47
  s_nop 0
  v_add_f32 v47, 1.0, v47
  v_rcp_f32 v47, v47
  s_nop 0
  v_mul_f32 v47, v47, v44
  s_mov_b32 s92, 0
  s_waitcnt vmcnt(0)
  v_cmp_ne_u32 s[52:53], s83, v25
  v_cmp_ne_u32 s[54:55], s83, v27
  v_cmp_ne_u32 s[56:57], s83, v29
  v_cmp_ne_u32 s[58:59], s83, v31
Lmp_127:
  s_or_b64 vcc, s[52:53], s[54:55]
  s_or_b64 vcc, vcc, s[56:57]
  s_or_b64 vcc, vcc, s[58:59]
  s_cbranch_scc0 Lmpd_128
  s_add_u32 s92, s92, 1
  s_cmp_ge_u32 s92, 40000
  s_cbranch_scc1 Lmpd_128
  s_sleep 1
  s_mov_b64 exec, s[52:53]
  s_cbranch_execz Lmps_129
  buffer_load_dwordx2 v[24:25], v10, s[76:79], s84 offen sc1
Lmps_129:
  s_mov_b64 exec, s[54:55]
  s_cbranch_execz Lmps_130
  buffer_load_dwordx2 v[26:27], v10, s[76:79], s85 offen sc1
Lmps_130:
  s_mov_b64 exec, s[56:57]
  s_cbranch_execz Lmps_131
  buffer_load_dwordx2 v[28:29], v10, s[76:79], s86 offen sc1
Lmps_131:
  s_mov_b64 exec, s[58:59]
  s_cbranch_execz Lmps_132
  buffer_load_dwordx2 v[30:31], v11, s[76:79], s87 offen sc1
Lmps_132:
  s_waitcnt vmcnt(0)
  s_mov_b64 exec, s[52:53]
  v_cmp_ne_u32 s[52:53], s83, v25
  s_mov_b64 exec, s[54:55]
  v_cmp_ne_u32 s[54:55], s83, v27
  s_mov_b64 exec, s[56:57]
  v_cmp_ne_u32 s[56:57], s83, v29
  s_mov_b64 exec, s[58:59]
  v_cmp_ne_u32 s[58:59], s83, v31
  s_mov_b64 exec, -1
  s_branch Lmp_127
Lmpd_128:
  v_mul_f32 v48, v24, v144
  v_mul_f32 v49, v24, v145
  v_mul_f32 v50, v24, v146
  v_mul_f32 v51, v24, v147
  v_mul_f32 v52, v24, v148
  v_mul_f32 v53, v24, v149
  v_mul_f32 v54, v24, v150
  v_mul_f32 v55, v24, v151
  v_fmac_f32 v48, v26, v152
  v_fmac_f32 v49, v26, v153
  v_fmac_f32 v50, v26, v154
  v_fmac_f32 v51, v26, v155
  v_fmac_f32 v52, v26, v156
  v_fmac_f32 v53, v26, v157
  v_fmac_f32 v54, v26, v158
  v_fmac_f32 v55, v26, v159
  v_fmac_f32 v48, v28, v160
  v_fmac_f32 v49, v28, v161
  v_fmac_f32 v50, v28, v162
  v_fmac_f32 v51, v28, v163
  v_fmac_f32 v52, v28, v164
  v_fmac_f32 v53, v28, v165
  v_fmac_f32 v54, v28, v166
  v_fmac_f32 v55, v28, v167
  v_fmac_f32 v48, v30, v168
  v_fmac_f32 v49, v30, v169
  v_fmac_f32 v50, v30, v170
  v_fmac_f32 v51, v30, v171
  v_fmac_f32 v52, v30, v172
  v_fmac_f32 v53, v30, v173
  v_fmac_f32 v54, v30, v174
  v_fmac_f32 v55, v30, v175
  v_permlane32_swap_b32 v48, v49
  v_permlane32_swap_b32 v50, v51
  v_permlane32_swap_b32 v52, v53
  v_permlane32_swap_b32 v54, v55
  v_add_f32 v48, v48, v49
  v_add_f32 v50, v50, v51
  v_add_f32 v52, v52, v53
  v_add_f32 v54, v54, v55
  v_permlane16_swap_b32 v48, v50
  s_nop 0
  v_permlane16_swap_b32 v52, v54
  v_add_f32 v48, v48, v50
  v_add_f32 v52, v52, v54
  s_nop 0
  v_add_f32_dpp v48, v48, v48 row_shr:1 row_mask:0xf bank_mask:0xf
  v_add_f32_dpp v52, v52, v52 row_shr:1 row_mask:0xf bank_mask:0xf
  s_nop 0
  v_add_f32_dpp v48, v48, v48 row_shr:2 row_mask:0xf bank_mask:0xf
  v_add_f32_dpp v52, v52, v52 row_shr:2 row_mask:0xf bank_mask:0xf
  s_nop 0
  v_add_f32_dpp v48, v48, v48 row_shr:4 row_mask:0xf bank_mask:0xf
  v_add_f32_dpp v52, v52, v52 row_shr:4 row_mask:0xf bank_mask:0xf
  s_nop 0
  v_add_f32_dpp v48, v48, v48 row_shr:8 row_mask:0xf bank_mask:0xf
  v_add_f32_dpp v52, v52, v52 row_shr:8 row_mask:0xf bank_mask:0xf
  s_mov_b32 exec_lo, 0x80008000
  s_mov_b32 exec_hi, 0x80008000
  ds_write_b32 v177, v48
  ds_write_b32 v177, v52 offset:16
  s_mov_b64 exec, -1
  s_waitcnt lgkmcnt(0)
  s_barrier
  s_cmp_lg_u32 s82, 0
  s_cbranch_scc1 Lnd_121
  ds_read_b32 v16, v179 offset:0
  ds_read_b32 v17, v179 offset:32
  ds_read_b32 v18, v179 offset:64
  ds_read_b32 v19, v179 offset:96
  ds_read_b32 v20, v179 offset:128
  ds_read_b32 v21, v179 offset:160
  ds_read_b32 v22, v179 offset:192
  ds_read_b32 v23, v179 offset:224
  s_waitcnt lgkmcnt(0)
  v_add_f32 v16, v16, v17
  v_add_f32 v18, v18, v19
  v_add_f32 v20, v20, v21
  v_add_f32 v22, v22, v23
  v_add_f32 v16, v16, v18
  v_add_f32 v20, v20, v22
  v_add_f32 v16, v16, v20
  v_fma_f32 v16, v16, v47, v46
  v_cvt_pk_bf16_f32 v16, v16, v16
  s_lshl_b32 s84, s97, 10
  s_lshl_b32 s85, s11, 4
  s_add_u32 s84, s84, s85
  s_mov_b32 exec_lo, 0x000000ff
  s_mov_b32 exec_hi, 0x00000000
  buffer_store_short v16, v180, s[72:75], s84 offen
  s_mov_b64 exec, -1
  s_cmp_lg_u32 s11, 0
  s_cbranch_scc1 Lnonce_133
  v_mov_b32 v16, s83
  v_mov_b32 v17, 0
  s_mov_b32 exec_lo, 0x00000001
  s_mov_b32 exec_hi, 0x00000000
  buffer_store_dword v16, v17, s[76:79], 0 offen
  s_mov_b64 exec, -1
Lnonce_133:
Lnd_121:
L_end:
  s_endpgm
.section .rodata,"a"
.p2align 6
.amdhsa_kernel adaLN_cond__mha_block__moe_arch_mod__prompt_kernel
  .amdhsa_next_free_vgpr 256
  .amdhsa_next_free_sgpr 102
  .amdhsa_accum_offset 256
  .amdhsa_group_segment_fixed_size 0
  .amdhsa_kernarg_size 104
  .amdhsa_user_sgpr_count 2
  .amdhsa_user_sgpr_kernarg_segment_ptr 1
  .amdhsa_system_sgpr_workgroup_id_x 1
.end_amdhsa_kernel
```
